```python
import torch

def _softmax(x, axis=-1):
    return torch.softmax(x, dim=axis)
def _gelu(x):
    return torch.nn.functional.gelu(x, approximate="tanh")
def _silu(x):
    return torch.nn.functional.silu(x)
def _sigmoid(x):
    return torch.sigmoid(x)
def _layernorm(x, axis=-1, eps=1e-5):
    m = x.mean(dim=axis, keepdim=True)
    v = x.var(dim=axis, keepdim=True, unbiased=False)
    return (x - m) / torch.sqrt(v + eps)
def _scatter_add(tgt, idx, src, axis=0):
    return tgt.clone().index_add_(axis, idx, src)
def _segment_sum(src, seg, n):
    out = torch.zeros((n,) + src.shape[1:], dtype=src.dtype)
    return out.index_add_(0, seg, src)
def _pad(x, pw):
    flat = tuple(v for pair in reversed(pw) for v in pair)
    return torch.nn.functional.pad(x, flat)

kernel_name = 'sequential_preLN__sliding_block_cached__dense_activation_squared_relu__decode'

def setup_inputs():

    _w = (lambda a: (lambda t: t.to(torch.bfloat16) if t.is_floating_point() else t)(torch.as_tensor(a)))
    def _A_setup():
        B, Sq, D = 1, 1, 576
        Hq, Hkv, Sk, Dh = 32, 16, 65536, 128
        assert Hq % Hkv == 0, (Hq, Hkv)
        return {
            "x": _w((lambda *s: torch.randn(*s, dtype=torch.bfloat16) * 0.05)(B, Sq, D)),
            "k_cache": _w((lambda *s: torch.randn(*s, dtype=torch.bfloat16) * 3.2)(B, Hkv, Sk, Dh)),
            "v_cache": _w((lambda *s: torch.randn(*s, dtype=torch.bfloat16) * 0.4)(B, Hkv, Sk, Dh)),
            "wq": _w((lambda *s: torch.randn(*s, dtype=torch.bfloat16) * 3.2)(D, Hq * Dh) * (D ** -0.5)),
            "wo": _w((lambda *s: torch.randn(*s, dtype=torch.bfloat16) * 0.4)(Hq * Dh, D) * ((Hq * Dh) ** -0.5)),
        }
    _A_in = _A_setup()

    def _B_setup():
        B, S, D, F = 1, 1, 576, 4608
        return {
            "x": _w((lambda *s: torch.randn(*s, dtype=torch.bfloat16) * 0.05)(B, S, D)),
            "w1": _w((lambda *s: torch.randn(*s, dtype=torch.bfloat16) * 0.05)(D, F)),
            "b1": _w((lambda *s: torch.randn(*s, dtype=torch.bfloat16) * 0.8)(F)),
            "w2": _w((lambda *s: torch.randn(*s, dtype=torch.bfloat16) * 0.05)(F, D)),
            "b2": _w((lambda *s: torch.randn(*s, dtype=torch.bfloat16) * 3.2)(D)),
        }
    _B_in = _B_setup()

    return {
        "A_x": _A_in["x"],
        "A_k_cache": _A_in["k_cache"],
        "A_v_cache": _A_in["v_cache"],
        "A_wq": _A_in["wq"],
        "A_wo": _A_in["wo"],
        "B_x": _B_in["x"],
        "B_w1": _B_in["w1"],
        "B_b1": _B_in["b1"],
        "B_w2": _B_in["w2"],
        "B_b2": _B_in["b2"],
    }

def reference(A_x, A_k_cache, A_v_cache, A_wq, A_wo, B_x, B_w1, B_b1, B_w2, B_b2):
    def _A_ref(x, k_cache, v_cache, wq, wo):
        B, Sq, D = x.shape
        Hq, Dh = 32, 128
        Hkv, Sk = k_cache.shape[1], k_cache.shape[2]
        W = min(4096, max(256, Sk // 4))
        rep = Hq // Hkv
        q = (lambda x, *d: x.permute(*d))((x @ wq).reshape(B, Sq, Hq, Dh), 0, 2, 1, 3)
        k = (lambda x, n, axis: torch.repeat_interleave(x, n, dim=axis))(k_cache[:, :, Sk - W:, :], rep, axis=1)
        v = (lambda x, n, axis: torch.repeat_interleave(x, n, dim=axis))(v_cache[:, :, Sk - W:, :], rep, axis=1)
        scores = torch.einsum("bhqd,bhkd->bhqk", q, k) * (Dh ** -0.5)
        p = _softmax(scores, axis=-1)
        o = torch.einsum("bhqk,bhkd->bhqd", p, v)
        return (lambda x, *d: x.permute(*d))(o, 0, 2, 1, 3).reshape(B, Sq, Hq * Dh) @ wo

    def _B_ref(x, w1, b1, w2, b2):
        h = torch.einsum("bsd,df->bsf", x, w1) + b1
        zero = torch.zeros_like(h)
        r = torch.where(h > zero, h, zero)
        h = r * r
        out = torch.einsum("bsf,fd->bsd", h, w2) + b2
        return out

    x = A_x
    h = x + _A_ref(_layernorm(x, axis=-1), A_k_cache, A_v_cache, A_wq, A_wo)
    h2 = h + _B_ref(_layernorm(h, axis=-1), B_w1, B_b1, B_w2, B_b2)
    return h2
```

```asm
; @launch kernel=k1_qproj_kernel grid=(64,1,1) block=(512,1,1) lds=16384
; @launch kernel=k2_attn_kernel grid=(256,1,1) block=(512,1,1) lds=33024
; @launch kernel=k3_wo_kernel grid=(256,1,1) block=(576,1,1) lds=18432
; @launch kernel=k4_ffn_kernel grid=(144,1,1) block=(576,1,1) lds=24576
; @launch kernel=k5_fin_kernel grid=(1,1,1) block=(576,1,1) lds=0
.amdgcn_target "amdgcn-amd-amdhsa--gfx950"
.text
.globl k1_qproj_kernel
.p2align 8
.type k1_qproj_kernel,@function
k1_qproj_kernel:
  s_cmp_ge_u32 s2, 64
  s_cbranch_scc1 K1_END
  s_load_dwordx2 s[4:5], s[0:1], 0
  s_load_dwordx2 s[6:7], s[0:1], 24
  s_load_dwordx2 s[8:9], s[0:1], 96
  s_waitcnt lgkmcnt(0)
  s_mov_b32 s12, s4
  s_and_b32 s13, s5, 0xffff
  s_mov_b32 s14, 1152
  s_mov_b32 s15, 0x00020000
  s_mov_b32 s16, s6
  s_and_b32 s17, s7, 0xffff
  s_mov_b32 s18, 4718592
  s_mov_b32 s19, 0x00020000
  s_mov_b32 s20, s8
  s_and_b32 s21, s9, 0xffff
  s_mov_b32 s22, 1073741824
  s_mov_b32 s23, 0x00020000
  v_and_b32 v1, 63, v0
  v_lshlrev_b32 v2, 1, v1
  buffer_load_ushort v10, v2, s[12:15], 0 offen offset:0
  buffer_load_ushort v11, v2, s[12:15], 0 offen offset:128
  buffer_load_ushort v12, v2, s[12:15], 0 offen offset:256
  buffer_load_ushort v13, v2, s[12:15], 0 offen offset:384
  buffer_load_ushort v14, v2, s[12:15], 0 offen offset:512
  buffer_load_ushort v15, v2, s[12:15], 0 offen offset:640
  buffer_load_ushort v16, v2, s[12:15], 0 offen offset:768
  buffer_load_ushort v17, v2, s[12:15], 0 offen offset:896
  buffer_load_ushort v18, v2, s[12:15], 0 offen offset:1024
  v_lshrrev_b32 v3, 3, v0
  v_lshlrev_b32 v5, 1, v3
  buffer_load_ushort v20, v5, s[12:15], 0 offen offset:0
  buffer_load_ushort v21, v5, s[12:15], 0 offen offset:128
  buffer_load_ushort v22, v5, s[12:15], 0 offen offset:256
  buffer_load_ushort v23, v5, s[12:15], 0 offen offset:384
  buffer_load_ushort v24, v5, s[12:15], 0 offen offset:512
  buffer_load_ushort v25, v5, s[12:15], 0 offen offset:640
  buffer_load_ushort v26, v5, s[12:15], 0 offen offset:768
  buffer_load_ushort v27, v5, s[12:15], 0 offen offset:896
  buffer_load_ushort v28, v5, s[12:15], 0 offen offset:1024
  v_lshlrev_b32 v4, 13, v3
  v_and_b32 v5, 7, v0
  v_lshlrev_b32 v5, 4, v5
  v_add_u32 v4, v4, v5
  s_lshl_b32 s24, s2, 7
  s_add_u32 s25, s24, 0
  s_add_u32 s26, s24, 524288
  s_add_u32 s27, s24, 1048576
  s_add_u32 s28, s24, 1572864
  s_add_u32 s29, s24, 2097152
  s_add_u32 s30, s24, 2621440
  s_add_u32 s31, s24, 3145728
  s_add_u32 s32, s24, 3670016
  s_add_u32 s33, s24, 4194304
  buffer_load_dwordx4 v[32:35], v4, s[16:19], s25 offen sc1 nt
  buffer_load_dwordx4 v[36:39], v4, s[16:19], s26 offen sc1 nt
  buffer_load_dwordx4 v[40:43], v4, s[16:19], s27 offen sc1 nt
  buffer_load_dwordx4 v[44:47], v4, s[16:19], s28 offen sc1 nt
  buffer_load_dwordx4 v[48:51], v4, s[16:19], s29 offen sc1 nt
  buffer_load_dwordx4 v[52:55], v4, s[16:19], s30 offen sc1 nt
  buffer_load_dwordx4 v[56:59], v4, s[16:19], s31 offen sc1 nt
  buffer_load_dwordx4 v[60:63], v4, s[16:19], s32 offen sc1 nt
  buffer_load_dwordx4 v[64:67], v4, s[16:19], s33 offen sc1 nt
  s_waitcnt vmcnt(9)
  v_lshlrev_b32 v10, 16, v10
  v_lshlrev_b32 v20, 16, v20
  v_lshlrev_b32 v11, 16, v11
  v_lshlrev_b32 v21, 16, v21
  v_lshlrev_b32 v12, 16, v12
  v_lshlrev_b32 v22, 16, v22
  v_lshlrev_b32 v13, 16, v13
  v_lshlrev_b32 v23, 16, v23
  v_lshlrev_b32 v14, 16, v14
  v_lshlrev_b32 v24, 16, v24
  v_lshlrev_b32 v15, 16, v15
  v_lshlrev_b32 v25, 16, v25
  v_lshlrev_b32 v16, 16, v16
  v_lshlrev_b32 v26, 16, v26
  v_lshlrev_b32 v17, 16, v17
  v_lshlrev_b32 v27, 16, v27
  v_lshlrev_b32 v18, 16, v18
  v_lshlrev_b32 v28, 16, v28
  v_add_f32 v6, v10, v11
  v_add_f32 v6, v6, v12
  v_add_f32 v6, v6, v13
  v_add_f32 v6, v6, v14
  v_add_f32 v6, v6, v15
  v_add_f32 v6, v6, v16
  v_add_f32 v6, v6, v17
  v_add_f32 v6, v6, v18
  s_nop 1
  v_add_f32_dpp v7, v6, v6 quad_perm:[1,0,3,2] row_mask:0xf bank_mask:0xf
  s_nop 1
  v_add_f32_dpp v6, v7, v7 quad_perm:[2,3,0,1] row_mask:0xf bank_mask:0xf
  s_nop 1
  v_add_f32_dpp v7, v6, v6 row_half_mirror row_mask:0xf bank_mask:0xf
  s_nop 1
  v_add_f32_dpp v6, v7, v7 row_mirror row_mask:0xf bank_mask:0xf
  s_nop 1
  v_readlane_b32 s40, v6, 0
  v_readlane_b32 s41, v6, 16
  v_readlane_b32 s42, v6, 32
  v_readlane_b32 s43, v6, 48
  s_nop 1
  v_mov_b32 v6, s40
  v_add_f32 v6, s41, v6
  v_add_f32 v6, s42, v6
  v_add_f32 v6, s43, v6
  v_mul_f32 v8, 0x3ae38e39, v6
  v_sub_f32 v7, v10, v8
  v_mul_f32 v6, v7, v7
  v_sub_f32 v7, v11, v8
  v_fmac_f32 v6, v7, v7
  v_sub_f32 v7, v12, v8
  v_fmac_f32 v6, v7, v7
  v_sub_f32 v7, v13, v8
  v_fmac_f32 v6, v7, v7
  v_sub_f32 v7, v14, v8
  v_fmac_f32 v6, v7, v7
  v_sub_f32 v7, v15, v8
  v_fmac_f32 v6, v7, v7
  v_sub_f32 v7, v16, v8
  v_fmac_f32 v6, v7, v7
  v_sub_f32 v7, v17, v8
  v_fmac_f32 v6, v7, v7
  v_sub_f32 v7, v18, v8
  v_fmac_f32 v6, v7, v7
  s_nop 1
  v_add_f32_dpp v7, v6, v6 quad_perm:[1,0,3,2] row_mask:0xf bank_mask:0xf
  s_nop 1
  v_add_f32_dpp v6, v7, v7 quad_perm:[2,3,0,1] row_mask:0xf bank_mask:0xf
  s_nop 1
  v_add_f32_dpp v7, v6, v6 row_half_mirror row_mask:0xf bank_mask:0xf
  s_nop 1
  v_add_f32_dpp v6, v7, v7 row_mirror row_mask:0xf bank_mask:0xf
  s_nop 1
  v_readlane_b32 s40, v6, 0
  v_readlane_b32 s41, v6, 16
  v_readlane_b32 s42, v6, 32
  v_readlane_b32 s43, v6, 48
  s_nop 1
  v_mov_b32 v6, s40
  v_add_f32 v6, s41, v6
  v_add_f32 v6, s42, v6
  v_add_f32 v6, s43, v6
  v_mov_b32 v7, 0x3727c5ac
  v_fmac_f32 v7, 0x3ae38e39, v6
  v_rsq_f32 v9, v7
  s_nop 1
  v_sub_f32 v20, v20, v8
  v_mul_f32 v20, v20, v9
  v_sub_f32 v21, v21, v8
  v_mul_f32 v21, v21, v9
  v_sub_f32 v22, v22, v8
  v_mul_f32 v22, v22, v9
  v_sub_f32 v23, v23, v8
  v_mul_f32 v23, v23, v9
  v_sub_f32 v24, v24, v8
  v_mul_f32 v24, v24, v9
  v_sub_f32 v25, v25, v8
  v_mul_f32 v25, v25, v9
  v_sub_f32 v26, v26, v8
  v_mul_f32 v26, v26, v9
  v_sub_f32 v27, v27, v8
  v_mul_f32 v27, v27, v9
  v_sub_f32 v28, v28, v8
  v_mul_f32 v28, v28, v9
  v_mov_b32 v80, 0
  v_mov_b32 v81, 0
  v_mov_b32 v82, 0
  v_mov_b32 v83, 0
  v_mov_b32 v84, 0
  v_mov_b32 v85, 0
  v_mov_b32 v86, 0
  v_mov_b32 v87, 0
  s_waitcnt vmcnt(8)
  v_lshlrev_b32 v6, 16, v32
  v_and_b32 v7, 0xffff0000, v32
  v_fmac_f32 v80, v6, v20
  v_fmac_f32 v81, v7, v20
  v_lshlrev_b32 v6, 16, v33
  v_and_b32 v7, 0xffff0000, v33
  v_fmac_f32 v82, v6, v20
  v_fmac_f32 v83, v7, v20
  v_lshlrev_b32 v6, 16, v34
  v_and_b32 v7, 0xffff0000, v34
  v_fmac_f32 v84, v6, v20
  v_fmac_f32 v85, v7, v20
  v_lshlrev_b32 v6, 16, v35
  v_and_b32 v7, 0xffff0000, v35
  v_fmac_f32 v86, v6, v20
  v_fmac_f32 v87, v7, v20
  s_waitcnt vmcnt(7)
  v_lshlrev_b32 v6, 16, v36
  v_and_b32 v7, 0xffff0000, v36
  v_fmac_f32 v80, v6, v21
  v_fmac_f32 v81, v7, v21
  v_lshlrev_b32 v6, 16, v37
  v_and_b32 v7, 0xffff0000, v37
  v_fmac_f32 v82, v6, v21
  v_fmac_f32 v83, v7, v21
  v_lshlrev_b32 v6, 16, v38
  v_and_b32 v7, 0xffff0000, v38
  v_fmac_f32 v84, v6, v21
  v_fmac_f32 v85, v7, v21
  v_lshlrev_b32 v6, 16, v39
  v_and_b32 v7, 0xffff0000, v39
  v_fmac_f32 v86, v6, v21
  v_fmac_f32 v87, v7, v21
  s_waitcnt vmcnt(6)
  v_lshlrev_b32 v6, 16, v40
  v_and_b32 v7, 0xffff0000, v40
  v_fmac_f32 v80, v6, v22
  v_fmac_f32 v81, v7, v22
  v_lshlrev_b32 v6, 16, v41
  v_and_b32 v7, 0xffff0000, v41
  v_fmac_f32 v82, v6, v22
  v_fmac_f32 v83, v7, v22
  v_lshlrev_b32 v6, 16, v42
  v_and_b32 v7, 0xffff0000, v42
  v_fmac_f32 v84, v6, v22
  v_fmac_f32 v85, v7, v22
  v_lshlrev_b32 v6, 16, v43
  v_and_b32 v7, 0xffff0000, v43
  v_fmac_f32 v86, v6, v22
  v_fmac_f32 v87, v7, v22
  s_waitcnt vmcnt(5)
  v_lshlrev_b32 v6, 16, v44
  v_and_b32 v7, 0xffff0000, v44
  v_fmac_f32 v80, v6, v23
  v_fmac_f32 v81, v7, v23
  v_lshlrev_b32 v6, 16, v45
  v_and_b32 v7, 0xffff0000, v45
  v_fmac_f32 v82, v6, v23
  v_fmac_f32 v83, v7, v23
  v_lshlrev_b32 v6, 16, v46
  v_and_b32 v7, 0xffff0000, v46
  v_fmac_f32 v84, v6, v23
  v_fmac_f32 v85, v7, v23
  v_lshlrev_b32 v6, 16, v47
  v_and_b32 v7, 0xffff0000, v47
  v_fmac_f32 v86, v6, v23
  v_fmac_f32 v87, v7, v23
  s_waitcnt vmcnt(4)
  v_lshlrev_b32 v6, 16, v48
  v_and_b32 v7, 0xffff0000, v48
  v_fmac_f32 v80, v6, v24
  v_fmac_f32 v81, v7, v24
  v_lshlrev_b32 v6, 16, v49
  v_and_b32 v7, 0xffff0000, v49
  v_fmac_f32 v82, v6, v24
  v_fmac_f32 v83, v7, v24
  v_lshlrev_b32 v6, 16, v50
  v_and_b32 v7, 0xffff0000, v50
  v_fmac_f32 v84, v6, v24
  v_fmac_f32 v85, v7, v24
  v_lshlrev_b32 v6, 16, v51
  v_and_b32 v7, 0xffff0000, v51
  v_fmac_f32 v86, v6, v24
  v_fmac_f32 v87, v7, v24
  s_waitcnt vmcnt(3)
  v_lshlrev_b32 v6, 16, v52
  v_and_b32 v7, 0xffff0000, v52
  v_fmac_f32 v80, v6, v25
  v_fmac_f32 v81, v7, v25
  v_lshlrev_b32 v6, 16, v53
  v_and_b32 v7, 0xffff0000, v53
  v_fmac_f32 v82, v6, v25
  v_fmac_f32 v83, v7, v25
  v_lshlrev_b32 v6, 16, v54
  v_and_b32 v7, 0xffff0000, v54
  v_fmac_f32 v84, v6, v25
  v_fmac_f32 v85, v7, v25
  v_lshlrev_b32 v6, 16, v55
  v_and_b32 v7, 0xffff0000, v55
  v_fmac_f32 v86, v6, v25
  v_fmac_f32 v87, v7, v25
  s_waitcnt vmcnt(2)
  v_lshlrev_b32 v6, 16, v56
  v_and_b32 v7, 0xffff0000, v56
  v_fmac_f32 v80, v6, v26
  v_fmac_f32 v81, v7, v26
  v_lshlrev_b32 v6, 16, v57
  v_and_b32 v7, 0xffff0000, v57
  v_fmac_f32 v82, v6, v26
  v_fmac_f32 v83, v7, v26
  v_lshlrev_b32 v6, 16, v58
  v_and_b32 v7, 0xffff0000, v58
  v_fmac_f32 v84, v6, v26
  v_fmac_f32 v85, v7, v26
  v_lshlrev_b32 v6, 16, v59
  v_and_b32 v7, 0xffff0000, v59
  v_fmac_f32 v86, v6, v26
  v_fmac_f32 v87, v7, v26
  s_waitcnt vmcnt(1)
  v_lshlrev_b32 v6, 16, v60
  v_and_b32 v7, 0xffff0000, v60
  v_fmac_f32 v80, v6, v27
  v_fmac_f32 v81, v7, v27
  v_lshlrev_b32 v6, 16, v61
  v_and_b32 v7, 0xffff0000, v61
  v_fmac_f32 v82, v6, v27
  v_fmac_f32 v83, v7, v27
  v_lshlrev_b32 v6, 16, v62
  v_and_b32 v7, 0xffff0000, v62
  v_fmac_f32 v84, v6, v27
  v_fmac_f32 v85, v7, v27
  v_lshlrev_b32 v6, 16, v63
  v_and_b32 v7, 0xffff0000, v63
  v_fmac_f32 v86, v6, v27
  v_fmac_f32 v87, v7, v27
  s_waitcnt vmcnt(0)
  v_lshlrev_b32 v6, 16, v64
  v_and_b32 v7, 0xffff0000, v64
  v_fmac_f32 v80, v6, v28
  v_fmac_f32 v81, v7, v28
  v_lshlrev_b32 v6, 16, v65
  v_and_b32 v7, 0xffff0000, v65
  v_fmac_f32 v82, v6, v28
  v_fmac_f32 v83, v7, v28
  v_lshlrev_b32 v6, 16, v66
  v_and_b32 v7, 0xffff0000, v66
  v_fmac_f32 v84, v6, v28
  v_fmac_f32 v85, v7, v28
  v_lshlrev_b32 v6, 16, v67
  v_and_b32 v7, 0xffff0000, v67
  v_fmac_f32 v86, v6, v28
  v_fmac_f32 v87, v7, v28
  v_lshlrev_b32 v4, 8, v3
  v_and_b32 v5, 7, v0
  v_lshlrev_b32 v5, 5, v5
  v_add_u32 v4, v4, v5
  ds_write_b128 v4, v[80:83]
  ds_write_b128 v4, v[84:87] offset:16
  s_waitcnt lgkmcnt(0)
  s_barrier
  v_cmp_gt_u32 vcc, 64, v0
  s_and_saveexec_b64 s[36:37], vcc
  s_cbranch_execz K1_END
  v_lshlrev_b32 v4, 2, v0
  ds_read_b32 v10, v4 offset:0
  ds_read_b32 v11, v4 offset:256
  ds_read_b32 v12, v4 offset:512
  ds_read_b32 v13, v4 offset:768
  ds_read_b32 v14, v4 offset:1024
  ds_read_b32 v15, v4 offset:1280
  ds_read_b32 v16, v4 offset:1536
  ds_read_b32 v17, v4 offset:1792
  ds_read_b32 v18, v4 offset:2048
  ds_read_b32 v19, v4 offset:2304
  ds_read_b32 v20, v4 offset:2560
  ds_read_b32 v21, v4 offset:2816
  ds_read_b32 v22, v4 offset:3072
  ds_read_b32 v23, v4 offset:3328
  ds_read_b32 v24, v4 offset:3584
  ds_read_b32 v25, v4 offset:3840
  s_waitcnt lgkmcnt(0)
  v_mov_b32 v6, v10
  v_add_f32 v6, v6, v11
  v_add_f32 v6, v6, v12
  v_add_f32 v6, v6, v13
  v_add_f32 v6, v6, v14
  v_add_f32 v6, v6, v15
  v_add_f32 v6, v6, v16
  v_add_f32 v6, v6, v17
  v_add_f32 v6, v6, v18
  v_add_f32 v6, v6, v19
  v_add_f32 v6, v6, v20
  v_add_f32 v6, v6, v21
  v_add_f32 v6, v6, v22
  v_add_f32 v6, v6, v23
  v_add_f32 v6, v6, v24
  v_add_f32 v6, v6, v25
  ds_read_b32 v10, v4 offset:4096
  ds_read_b32 v11, v4 offset:4352
  ds_read_b32 v12, v4 offset:4608
  ds_read_b32 v13, v4 offset:4864
  ds_read_b32 v14, v4 offset:5120
  ds_read_b32 v15, v4 offset:5376
  ds_read_b32 v16, v4 offset:5632
  ds_read_b32 v17, v4 offset:5888
  ds_read_b32 v18, v4 offset:6144
  ds_read_b32 v19, v4 offset:6400
  ds_read_b32 v20, v4 offset:6656
  ds_read_b32 v21, v4 offset:6912
  ds_read_b32 v22, v4 offset:7168
  ds_read_b32 v23, v4 offset:7424
  ds_read_b32 v24, v4 offset:7680
  ds_read_b32 v25, v4 offset:7936
  s_waitcnt lgkmcnt(0)
  v_add_f32 v6, v6, v10
  v_add_f32 v6, v6, v11
  v_add_f32 v6, v6, v12
  v_add_f32 v6, v6, v13
  v_add_f32 v6, v6, v14
  v_add_f32 v6, v6, v15
  v_add_f32 v6, v6, v16
  v_add_f32 v6, v6, v17
  v_add_f32 v6, v6, v18
  v_add_f32 v6, v6, v19
  v_add_f32 v6, v6, v20
  v_add_f32 v6, v6, v21
  v_add_f32 v6, v6, v22
  v_add_f32 v6, v6, v23
  v_add_f32 v6, v6, v24
  v_add_f32 v6, v6, v25
  ds_read_b32 v10, v4 offset:8192
  ds_read_b32 v11, v4 offset:8448
  ds_read_b32 v12, v4 offset:8704
  ds_read_b32 v13, v4 offset:8960
  ds_read_b32 v14, v4 offset:9216
  ds_read_b32 v15, v4 offset:9472
  ds_read_b32 v16, v4 offset:9728
  ds_read_b32 v17, v4 offset:9984
  ds_read_b32 v18, v4 offset:10240
  ds_read_b32 v19, v4 offset:10496
  ds_read_b32 v20, v4 offset:10752
  ds_read_b32 v21, v4 offset:11008
  ds_read_b32 v22, v4 offset:11264
  ds_read_b32 v23, v4 offset:11520
  ds_read_b32 v24, v4 offset:11776
  ds_read_b32 v25, v4 offset:12032
  s_waitcnt lgkmcnt(0)
  v_add_f32 v6, v6, v10
  v_add_f32 v6, v6, v11
  v_add_f32 v6, v6, v12
  v_add_f32 v6, v6, v13
  v_add_f32 v6, v6, v14
  v_add_f32 v6, v6, v15
  v_add_f32 v6, v6, v16
  v_add_f32 v6, v6, v17
  v_add_f32 v6, v6, v18
  v_add_f32 v6, v6, v19
  v_add_f32 v6, v6, v20
  v_add_f32 v6, v6, v21
  v_add_f32 v6, v6, v22
  v_add_f32 v6, v6, v23
  v_add_f32 v6, v6, v24
  v_add_f32 v6, v6, v25
  ds_read_b32 v10, v4 offset:12288
  ds_read_b32 v11, v4 offset:12544
  ds_read_b32 v12, v4 offset:12800
  ds_read_b32 v13, v4 offset:13056
  ds_read_b32 v14, v4 offset:13312
  ds_read_b32 v15, v4 offset:13568
  ds_read_b32 v16, v4 offset:13824
  ds_read_b32 v17, v4 offset:14080
  ds_read_b32 v18, v4 offset:14336
  ds_read_b32 v19, v4 offset:14592
  ds_read_b32 v20, v4 offset:14848
  ds_read_b32 v21, v4 offset:15104
  ds_read_b32 v22, v4 offset:15360
  ds_read_b32 v23, v4 offset:15616
  ds_read_b32 v24, v4 offset:15872
  ds_read_b32 v25, v4 offset:16128
  s_waitcnt lgkmcnt(0)
  v_add_f32 v6, v6, v10
  v_add_f32 v6, v6, v11
  v_add_f32 v6, v6, v12
  v_add_f32 v6, v6, v13
  v_add_f32 v6, v6, v14
  v_add_f32 v6, v6, v15
  v_add_f32 v6, v6, v16
  v_add_f32 v6, v6, v17
  v_add_f32 v6, v6, v18
  v_add_f32 v6, v6, v19
  v_add_f32 v6, v6, v20
  v_add_f32 v6, v6, v21
  v_add_f32 v6, v6, v22
  v_add_f32 v6, v6, v23
  v_add_f32 v6, v6, v24
  v_add_f32 v6, v6, v25
  s_lshl_b32 s24, s2, 8
  buffer_store_dword v6, v4, s[20:23], s24 offen offset:0
K1_END:
  s_endpgm
.section .rodata,"a"
.p2align 6
.amdhsa_kernel k1_qproj_kernel
  .amdhsa_next_free_vgpr 96
  .amdhsa_next_free_sgpr 48
  .amdhsa_accum_offset 96
  .amdhsa_group_segment_fixed_size 0
  .amdhsa_kernarg_size 104
  .amdhsa_user_sgpr_count 2
  .amdhsa_user_sgpr_kernarg_segment_ptr 1
  .amdhsa_system_sgpr_workgroup_id_x 1
.end_amdhsa_kernel
.text
.globl k2_attn_kernel
.p2align 8
.type k2_attn_kernel,@function
k2_attn_kernel:
  s_cmp_ge_u32 s2, 256
  s_cbranch_scc1 K2_END
  s_load_dwordx2 s[4:5], s[0:1], 8
  s_load_dwordx2 s[6:7], s[0:1], 16
  s_load_dwordx2 s[8:9], s[0:1], 96
  s_waitcnt lgkmcnt(0)
  s_mov_b32 s12, s4
  s_and_b32 s13, s5, 0xffff
  s_mov_b32 s14, 268435456
  s_mov_b32 s15, 0x00020000
  s_mov_b32 s16, s6
  s_and_b32 s17, s7, 0xffff
  s_mov_b32 s18, 268435456
  s_mov_b32 s19, 0x00020000
  s_mov_b32 s20, s8
  s_and_b32 s21, s9, 0xffff
  s_mov_b32 s22, 1073741824
  s_mov_b32 s23, 0x00020000
  s_and_b32 s30, s2, 7
  s_lshl_b32 s30, s30, 1
  s_lshr_b32 s31, s2, 3
  s_and_b32 s31, s31, 1
  s_or_b32 s30, s30, s31
  s_lshr_b32 s31, s2, 4
  s_lshl_b32 s32, s30, 24
  s_lshl_b32 s33, s31, 16
  s_add_u32 s32, s32, s33
  s_add_u32 s32, s32, 15728640
  s_add_u32 s33, s32, 4096
  s_cmp_ge_u32 s2, 9
  s_cbranch_scc1 K2_NOZ
  v_mov_b32 v4, 0
  v_mov_b32 v5, 0
  v_mov_b32 v6, 0
  v_mov_b32 v7, 0
  v_lshlrev_b32 v1, 4, v0
  s_lshl_b32 s34, s2, 13
  s_add_u32 s34, s34, 1048576
  buffer_store_dwordx4 v[4:7], v1, s[20:23], s34 offen
K2_NOZ:
  v_and_b32 v1, 63, v0
  v_lshrrev_b32 v2, 6, v0
  v_and_b32 v3, 15, v0
  v_lshlrev_b32 v3, 5, v3
  s_lshl_b32 s34, s30, 10
  buffer_load_dwordx4 v[96:99], v3, s[20:23], s34 offen offset:0
  buffer_load_dwordx4 v[100:103], v3, s[20:23], s34 offen offset:16
  buffer_load_dwordx4 v[104:107], v3, s[20:23], s34 offen offset:512
  buffer_load_dwordx4 v[108:111], v3, s[20:23], s34 offen offset:528
  v_lshlrev_b32 v4, 13, v2
  v_lshlrev_b32 v5, 4, v1
  v_add_u32 v4, v4, v5
  buffer_load_dwordx4 v[32:35], v4, s[12:15], s32 offen offset:0 sc1 nt
  buffer_load_dwordx4 v[36:39], v4, s[12:15], s32 offen offset:1024 sc1 nt
  buffer_load_dwordx4 v[40:43], v4, s[12:15], s32 offen offset:2048 sc1 nt
  buffer_load_dwordx4 v[44:47], v4, s[12:15], s32 offen offset:3072 sc1 nt
  buffer_load_dwordx4 v[48:51], v4, s[12:15], s33 offen offset:0 sc1 nt
  buffer_load_dwordx4 v[52:55], v4, s[12:15], s33 offen offset:1024 sc1 nt
  buffer_load_dwordx4 v[56:59], v4, s[12:15], s33 offen offset:2048 sc1 nt
  buffer_load_dwordx4 v[60:63], v4, s[12:15], s33 offen offset:3072 sc1 nt
  buffer_load_dwordx4 v[64:67], v4, s[16:19], s32 offen offset:0 sc1 nt
  buffer_load_dwordx4 v[68:71], v4, s[16:19], s32 offen offset:1024 sc1 nt
  buffer_load_dwordx4 v[72:75], v4, s[16:19], s32 offen offset:2048 sc1 nt
  buffer_load_dwordx4 v[76:79], v4, s[16:19], s32 offen offset:3072 sc1 nt
  buffer_load_dwordx4 v[80:83], v4, s[16:19], s33 offen offset:0 sc1 nt
  buffer_load_dwordx4 v[84:87], v4, s[16:19], s33 offen offset:1024 sc1 nt
  buffer_load_dwordx4 v[88:91], v4, s[16:19], s33 offen offset:2048 sc1 nt
  buffer_load_dwordx4 v[92:95], v4, s[16:19], s33 offen offset:3072 sc1 nt
  s_waitcnt vmcnt(16)
  v_cvt_pk_bf16_f32 v112, v96, v97
  v_cvt_pk_bf16_f32 v113, v98, v99
  v_cvt_pk_bf16_f32 v114, v100, v101
  v_cvt_pk_bf16_f32 v115, v102, v103
  v_cvt_pk_bf16_f32 v116, v104, v105
  v_cvt_pk_bf16_f32 v117, v106, v107
  v_cvt_pk_bf16_f32 v118, v108, v109
  v_cvt_pk_bf16_f32 v119, v110, v111
  s_nop 1
  s_waitcnt vmcnt(15)
  v_dot2_f32_bf16 v120, v32, v112, 0
  v_dot2_f32_bf16 v128, v32, v116, 0
  v_dot2_f32_bf16 v120, v33, v113, v120
  v_dot2_f32_bf16 v128, v33, v117, v128
  v_dot2_f32_bf16 v120, v34, v114, v120
  v_dot2_f32_bf16 v128, v34, v118, v128
  v_dot2_f32_bf16 v120, v35, v115, v120
  v_dot2_f32_bf16 v128, v35, v119, v128
  s_waitcnt vmcnt(14)
  v_dot2_f32_bf16 v121, v36, v112, 0
  v_dot2_f32_bf16 v129, v36, v116, 0
  v_dot2_f32_bf16 v121, v37, v113, v121
  v_dot2_f32_bf16 v129, v37, v117, v129
  v_dot2_f32_bf16 v121, v38, v114, v121
  v_dot2_f32_bf16 v129, v38, v118, v129
  v_dot2_f32_bf16 v121, v39, v115, v121
  v_dot2_f32_bf16 v129, v39, v119, v129
  s_waitcnt vmcnt(13)
  v_dot2_f32_bf16 v122, v40, v112, 0
  v_dot2_f32_bf16 v130, v40, v116, 0
  v_dot2_f32_bf16 v122, v41, v113, v122
  v_dot2_f32_bf16 v130, v41, v117, v130
  v_dot2_f32_bf16 v122, v42, v114, v122
  v_dot2_f32_bf16 v130, v42, v118, v130
  v_dot2_f32_bf16 v122, v43, v115, v122
  v_dot2_f32_bf16 v130, v43, v119, v130
  s_waitcnt vmcnt(12)
  v_dot2_f32_bf16 v123, v44, v112, 0
  v_dot2_f32_bf16 v131, v44, v116, 0
  v_dot2_f32_bf16 v123, v45, v113, v123
  v_dot2_f32_bf16 v131, v45, v117, v131
  v_dot2_f32_bf16 v123, v46, v114, v123
  v_dot2_f32_bf16 v131, v46, v118, v131
  v_dot2_f32_bf16 v123, v47, v115, v123
  v_dot2_f32_bf16 v131, v47, v119, v131
  s_waitcnt vmcnt(11)
  v_dot2_f32_bf16 v124, v48, v112, 0
  v_dot2_f32_bf16 v132, v48, v116, 0
  v_dot2_f32_bf16 v124, v49, v113, v124
  v_dot2_f32_bf16 v132, v49, v117, v132
  v_dot2_f32_bf16 v124, v50, v114, v124
  v_dot2_f32_bf16 v132, v50, v118, v132
  v_dot2_f32_bf16 v124, v51, v115, v124
  v_dot2_f32_bf16 v132, v51, v119, v132
  s_waitcnt vmcnt(10)
  v_dot2_f32_bf16 v125, v52, v112, 0
  v_dot2_f32_bf16 v133, v52, v116, 0
  v_dot2_f32_bf16 v125, v53, v113, v125
  v_dot2_f32_bf16 v133, v53, v117, v133
  v_dot2_f32_bf16 v125, v54, v114, v125
  v_dot2_f32_bf16 v133, v54, v118, v133
  v_dot2_f32_bf16 v125, v55, v115, v125
  v_dot2_f32_bf16 v133, v55, v119, v133
  s_waitcnt vmcnt(9)
  v_dot2_f32_bf16 v126, v56, v112, 0
  v_dot2_f32_bf16 v134, v56, v116, 0
  v_dot2_f32_bf16 v126, v57, v113, v126
  v_dot2_f32_bf16 v134, v57, v117, v134
  v_dot2_f32_bf16 v126, v58, v114, v126
  v_dot2_f32_bf16 v134, v58, v118, v134
  v_dot2_f32_bf16 v126, v59, v115, v126
  v_dot2_f32_bf16 v134, v59, v119, v134
  s_waitcnt vmcnt(8)
  v_dot2_f32_bf16 v127, v60, v112, 0
  v_dot2_f32_bf16 v135, v60, v116, 0
  v_dot2_f32_bf16 v127, v61, v113, v127
  v_dot2_f32_bf16 v135, v61, v117, v135
  v_dot2_f32_bf16 v127, v62, v114, v127
  v_dot2_f32_bf16 v135, v62, v118, v135
  v_dot2_f32_bf16 v127, v63, v115, v127
  v_dot2_f32_bf16 v135, v63, v119, v135
  s_nop 3
  v_add_f32_dpp v120, v120, v120 quad_perm:[1,0,3,2] row_mask:0xf bank_mask:0xf
  v_add_f32_dpp v121, v121, v121 quad_perm:[1,0,3,2] row_mask:0xf bank_mask:0xf
  v_add_f32_dpp v122, v122, v122 quad_perm:[1,0,3,2] row_mask:0xf bank_mask:0xf
  v_add_f32_dpp v123, v123, v123 quad_perm:[1,0,3,2] row_mask:0xf bank_mask:0xf
  v_add_f32_dpp v124, v124, v124 quad_perm:[1,0,3,2] row_mask:0xf bank_mask:0xf
  v_add_f32_dpp v125, v125, v125 quad_perm:[1,0,3,2] row_mask:0xf bank_mask:0xf
  v_add_f32_dpp v126, v126, v126 quad_perm:[1,0,3,2] row_mask:0xf bank_mask:0xf
  v_add_f32_dpp v127, v127, v127 quad_perm:[1,0,3,2] row_mask:0xf bank_mask:0xf
  v_add_f32_dpp v128, v128, v128 quad_perm:[1,0,3,2] row_mask:0xf bank_mask:0xf
  v_add_f32_dpp v129, v129, v129 quad_perm:[1,0,3,2] row_mask:0xf bank_mask:0xf
  v_add_f32_dpp v130, v130, v130 quad_perm:[1,0,3,2] row_mask:0xf bank_mask:0xf
  v_add_f32_dpp v131, v131, v131 quad_perm:[1,0,3,2] row_mask:0xf bank_mask:0xf
  v_add_f32_dpp v132, v132, v132 quad_perm:[1,0,3,2] row_mask:0xf bank_mask:0xf
  v_add_f32_dpp v133, v133, v133 quad_perm:[1,0,3,2] row_mask:0xf bank_mask:0xf
  v_add_f32_dpp v134, v134, v134 quad_perm:[1,0,3,2] row_mask:0xf bank_mask:0xf
  v_add_f32_dpp v135, v135, v135 quad_perm:[1,0,3,2] row_mask:0xf bank_mask:0xf
  v_add_f32_dpp v120, v120, v120 quad_perm:[2,3,0,1] row_mask:0xf bank_mask:0xf
  v_add_f32_dpp v121, v121, v121 quad_perm:[2,3,0,1] row_mask:0xf bank_mask:0xf
  v_add_f32_dpp v122, v122, v122 quad_perm:[2,3,0,1] row_mask:0xf bank_mask:0xf
  v_add_f32_dpp v123, v123, v123 quad_perm:[2,3,0,1] row_mask:0xf bank_mask:0xf
  v_add_f32_dpp v124, v124, v124 quad_perm:[2,3,0,1] row_mask:0xf bank_mask:0xf
  v_add_f32_dpp v125, v125, v125 quad_perm:[2,3,0,1] row_mask:0xf bank_mask:0xf
  v_add_f32_dpp v126, v126, v126 quad_perm:[2,3,0,1] row_mask:0xf bank_mask:0xf
  v_add_f32_dpp v127, v127, v127 quad_perm:[2,3,0,1] row_mask:0xf bank_mask:0xf
  v_add_f32_dpp v128, v128, v128 quad_perm:[2,3,0,1] row_mask:0xf bank_mask:0xf
  v_add_f32_dpp v129, v129, v129 quad_perm:[2,3,0,1] row_mask:0xf bank_mask:0xf
  v_add_f32_dpp v130, v130, v130 quad_perm:[2,3,0,1] row_mask:0xf bank_mask:0xf
  v_add_f32_dpp v131, v131, v131 quad_perm:[2,3,0,1] row_mask:0xf bank_mask:0xf
  v_add_f32_dpp v132, v132, v132 quad_perm:[2,3,0,1] row_mask:0xf bank_mask:0xf
  v_add_f32_dpp v133, v133, v133 quad_perm:[2,3,0,1] row_mask:0xf bank_mask:0xf
  v_add_f32_dpp v134, v134, v134 quad_perm:[2,3,0,1] row_mask:0xf bank_mask:0xf
  v_add_f32_dpp v135, v135, v135 quad_perm:[2,3,0,1] row_mask:0xf bank_mask:0xf
  v_add_f32_dpp v120, v120, v120 row_half_mirror row_mask:0xf bank_mask:0xf
  v_add_f32_dpp v121, v121, v121 row_half_mirror row_mask:0xf bank_mask:0xf
  v_add_f32_dpp v122, v122, v122 row_half_mirror row_mask:0xf bank_mask:0xf
  v_add_f32_dpp v123, v123, v123 row_half_mirror row_mask:0xf bank_mask:0xf
  v_add_f32_dpp v124, v124, v124 row_half_mirror row_mask:0xf bank_mask:0xf
  v_add_f32_dpp v125, v125, v125 row_half_mirror row_mask:0xf bank_mask:0xf
  v_add_f32_dpp v126, v126, v126 row_half_mirror row_mask:0xf bank_mask:0xf
  v_add_f32_dpp v127, v127, v127 row_half_mirror row_mask:0xf bank_mask:0xf
  v_add_f32_dpp v128, v128, v128 row_half_mirror row_mask:0xf bank_mask:0xf
  v_add_f32_dpp v129, v129, v129 row_half_mirror row_mask:0xf bank_mask:0xf
  v_add_f32_dpp v130, v130, v130 row_half_mirror row_mask:0xf bank_mask:0xf
  v_add_f32_dpp v131, v131, v131 row_half_mirror row_mask:0xf bank_mask:0xf
  v_add_f32_dpp v132, v132, v132 row_half_mirror row_mask:0xf bank_mask:0xf
  v_add_f32_dpp v133, v133, v133 row_half_mirror row_mask:0xf bank_mask:0xf
  v_add_f32_dpp v134, v134, v134 row_half_mirror row_mask:0xf bank_mask:0xf
  v_add_f32_dpp v135, v135, v135 row_half_mirror row_mask:0xf bank_mask:0xf
  v_add_f32_dpp v120, v120, v120 row_mirror row_mask:0xf bank_mask:0xf
  v_add_f32_dpp v121, v121, v121 row_mirror row_mask:0xf bank_mask:0xf
  v_add_f32_dpp v122, v122, v122 row_mirror row_mask:0xf bank_mask:0xf
  v_add_f32_dpp v123, v123, v123 row_mirror row_mask:0xf bank_mask:0xf
  v_add_f32_dpp v124, v124, v124 row_mirror row_mask:0xf bank_mask:0xf
  v_add_f32_dpp v125, v125, v125 row_mirror row_mask:0xf bank_mask:0xf
  v_add_f32_dpp v126, v126, v126 row_mirror row_mask:0xf bank_mask:0xf
  v_add_f32_dpp v127, v127, v127 row_mirror row_mask:0xf bank_mask:0xf
  v_add_f32_dpp v128, v128, v128 row_mirror row_mask:0xf bank_mask:0xf
  v_add_f32_dpp v129, v129, v129 row_mirror row_mask:0xf bank_mask:0xf
  v_add_f32_dpp v130, v130, v130 row_mirror row_mask:0xf bank_mask:0xf
  v_add_f32_dpp v131, v131, v131 row_mirror row_mask:0xf bank_mask:0xf
  v_add_f32_dpp v132, v132, v132 row_mirror row_mask:0xf bank_mask:0xf
  v_add_f32_dpp v133, v133, v133 row_mirror row_mask:0xf bank_mask:0xf
  v_add_f32_dpp v134, v134, v134 row_mirror row_mask:0xf bank_mask:0xf
  v_add_f32_dpp v135, v135, v135 row_mirror row_mask:0xf bank_mask:0xf
  s_nop 1
  v_max3_f32 v152, v120, v121, v122
  v_max3_f32 v152, v152, v123, v124
  v_max3_f32 v152, v152, v125, v126
  v_max_f32 v152, v152, v127
  v_max3_f32 v153, v128, v129, v130
  v_max3_f32 v153, v153, v131, v132
  v_max3_f32 v153, v153, v133, v134
  v_max_f32 v153, v153, v135
  s_nop 1
  v_readlane_b32 s40, v152, 0
  v_readlane_b32 s41, v152, 16
  v_readlane_b32 s42, v152, 32
  v_readlane_b32 s43, v152, 48
  v_readlane_b32 s44, v153, 0
  v_readlane_b32 s45, v153, 16
  v_readlane_b32 s46, v153, 32
  v_readlane_b32 s47, v153, 48
  s_nop 1
  v_mov_b32 v152, s40
  v_max_f32 v152, s41, v152
  v_max_f32 v152, s42, v152
  v_max_f32 v152, s43, v152
  v_mov_b32 v153, s44
  v_max_f32 v153, s45, v153
  v_max_f32 v153, s46, v153
  v_max_f32 v153, s47, v153
  v_mov_b32 v154, 0x3e0293ee
  v_sub_f32 v120, v120, v152
  v_mul_f32 v120, v154, v120
  v_exp_f32 v120, v120
  v_sub_f32 v121, v121, v152
  v_mul_f32 v121, v154, v121
  v_exp_f32 v121, v121
  v_sub_f32 v122, v122, v152
  v_mul_f32 v122, v154, v122
  v_exp_f32 v122, v122
  v_sub_f32 v123, v123, v152
  v_mul_f32 v123, v154, v123
  v_exp_f32 v123, v123
  v_sub_f32 v124, v124, v152
  v_mul_f32 v124, v154, v124
  v_exp_f32 v124, v124
  v_sub_f32 v125, v125, v152
  v_mul_f32 v125, v154, v125
  v_exp_f32 v125, v125
  v_sub_f32 v126, v126, v152
  v_mul_f32 v126, v154, v126
  v_exp_f32 v126, v126
  v_sub_f32 v127, v127, v152
  v_mul_f32 v127, v154, v127
  v_exp_f32 v127, v127
  v_sub_f32 v128, v128, v153
  v_mul_f32 v128, v154, v128
  v_exp_f32 v128, v128
  v_sub_f32 v129, v129, v153
  v_mul_f32 v129, v154, v129
  v_exp_f32 v129, v129
  v_sub_f32 v130, v130, v153
  v_mul_f32 v130, v154, v130
  v_exp_f32 v130, v130
  v_sub_f32 v131, v131, v153
  v_mul_f32 v131, v154, v131
  v_exp_f32 v131, v131
  v_sub_f32 v132, v132, v153
  v_mul_f32 v132, v154, v132
  v_exp_f32 v132, v132
  v_sub_f32 v133, v133, v153
  v_mul_f32 v133, v154, v133
  v_exp_f32 v133, v133
  v_sub_f32 v134, v134, v153
  v_mul_f32 v134, v154, v134
  v_exp_f32 v134, v134
  v_sub_f32 v135, v135, v153
  v_mul_f32 v135, v154, v135
  v_exp_f32 v135, v135
  s_nop 1
  v_add_f32 v155, v120, v121
  v_add_f32 v155, v155, v122
  v_add_f32 v155, v155, v123
  v_add_f32 v155, v155, v124
  v_add_f32 v155, v155, v125
  v_add_f32 v155, v155, v126
  v_add_f32 v155, v155, v127
  v_add_f32 v156, v128, v129
  v_add_f32 v156, v156, v130
  v_add_f32 v156, v156, v131
  v_add_f32 v156, v156, v132
  v_add_f32 v156, v156, v133
  v_add_f32 v156, v156, v134
  v_add_f32 v156, v156, v135
  s_nop 1
  v_readlane_b32 s40, v155, 0
  v_readlane_b32 s41, v155, 16
  v_readlane_b32 s42, v155, 32
  v_readlane_b32 s43, v155, 48
  v_readlane_b32 s44, v156, 0
  v_readlane_b32 s45, v156, 16
  v_readlane_b32 s46, v156, 32
  v_readlane_b32 s47, v156, 48
  s_nop 1
  v_mov_b32 v155, s40
  v_add_f32 v155, s41, v155
  v_add_f32 v155, s42, v155
  v_add_f32 v155, s43, v155
  v_mov_b32 v156, s44
  v_add_f32 v156, s45, v156
  v_add_f32 v156, s46, v156
  v_add_f32 v156, s47, v156
  v_mov_b32 v136, 0
  v_mov_b32 v137, 0
  v_mov_b32 v138, 0
  v_mov_b32 v139, 0
  v_mov_b32 v140, 0
  v_mov_b32 v141, 0
  v_mov_b32 v142, 0
  v_mov_b32 v143, 0
  v_mov_b32 v144, 0
  v_mov_b32 v145, 0
  v_mov_b32 v146, 0
  v_mov_b32 v147, 0
  v_mov_b32 v148, 0
  v_mov_b32 v149, 0
  v_mov_b32 v150, 0
  v_mov_b32 v151, 0
  s_waitcnt vmcnt(7)
  v_lshlrev_b32 v160, 16, v64
  v_and_b32 v161, 0xffff0000, v64
  v_lshlrev_b32 v162, 16, v65
  v_and_b32 v163, 0xffff0000, v65
  v_lshlrev_b32 v164, 16, v66
  v_and_b32 v165, 0xffff0000, v66
  v_lshlrev_b32 v166, 16, v67
  v_and_b32 v167, 0xffff0000, v67
  v_pk_fma_f32 v[136:137], v[160:161], v[120:121], v[136:137] op_sel_hi:[1,0,1]
  v_pk_fma_f32 v[138:139], v[162:163], v[120:121], v[138:139] op_sel_hi:[1,0,1]
  v_pk_fma_f32 v[140:141], v[164:165], v[120:121], v[140:141] op_sel_hi:[1,0,1]
  v_pk_fma_f32 v[142:143], v[166:167], v[120:121], v[142:143] op_sel_hi:[1,0,1]
  v_pk_fma_f32 v[144:145], v[160:161], v[128:129], v[144:145] op_sel_hi:[1,0,1]
  v_pk_fma_f32 v[146:147], v[162:163], v[128:129], v[146:147] op_sel_hi:[1,0,1]
  v_pk_fma_f32 v[148:149], v[164:165], v[128:129], v[148:149] op_sel_hi:[1,0,1]
  v_pk_fma_f32 v[150:151], v[166:167], v[128:129], v[150:151] op_sel_hi:[1,0,1]
  s_waitcnt vmcnt(6)
  v_lshlrev_b32 v160, 16, v68
  v_and_b32 v161, 0xffff0000, v68
  v_lshlrev_b32 v162, 16, v69
  v_and_b32 v163, 0xffff0000, v69
  v_lshlrev_b32 v164, 16, v70
  v_and_b32 v165, 0xffff0000, v70
  v_lshlrev_b32 v166, 16, v71
  v_and_b32 v167, 0xffff0000, v71
  v_pk_fma_f32 v[136:137], v[160:161], v[120:121], v[136:137] op_sel:[0,1,0] op_sel_hi:[1,1,1]
  v_pk_fma_f32 v[138:139], v[162:163], v[120:121], v[138:139] op_sel:[0,1,0] op_sel_hi:[1,1,1]
  v_pk_fma_f32 v[140:141], v[164:165], v[120:121], v[140:141] op_sel:[0,1,0] op_sel_hi:[1,1,1]
  v_pk_fma_f32 v[142:143], v[166:167], v[120:121], v[142:143] op_sel:[0,1,0] op_sel_hi:[1,1,1]
  v_pk_fma_f32 v[144:145], v[160:161], v[128:129], v[144:145] op_sel:[0,1,0] op_sel_hi:[1,1,1]
  v_pk_fma_f32 v[146:147], v[162:163], v[128:129], v[146:147] op_sel:[0,1,0] op_sel_hi:[1,1,1]
  v_pk_fma_f32 v[148:149], v[164:165], v[128:129], v[148:149] op_sel:[0,1,0] op_sel_hi:[1,1,1]
  v_pk_fma_f32 v[150:151], v[166:167], v[128:129], v[150:151] op_sel:[0,1,0] op_sel_hi:[1,1,1]
  s_waitcnt vmcnt(5)
  v_lshlrev_b32 v160, 16, v72
  v_and_b32 v161, 0xffff0000, v72
  v_lshlrev_b32 v162, 16, v73
  v_and_b32 v163, 0xffff0000, v73
  v_lshlrev_b32 v164, 16, v74
  v_and_b32 v165, 0xffff0000, v74
  v_lshlrev_b32 v166, 16, v75
  v_and_b32 v167, 0xffff0000, v75
  v_pk_fma_f32 v[136:137], v[160:161], v[122:123], v[136:137] op_sel_hi:[1,0,1]
  v_pk_fma_f32 v[138:139], v[162:163], v[122:123], v[138:139] op_sel_hi:[1,0,1]
  v_pk_fma_f32 v[140:141], v[164:165], v[122:123], v[140:141] op_sel_hi:[1,0,1]
  v_pk_fma_f32 v[142:143], v[166:167], v[122:123], v[142:143] op_sel_hi:[1,0,1]
  v_pk_fma_f32 v[144:145], v[160:161], v[130:131], v[144:145] op_sel_hi:[1,0,1]
  v_pk_fma_f32 v[146:147], v[162:163], v[130:131], v[146:147] op_sel_hi:[1,0,1]
  v_pk_fma_f32 v[148:149], v[164:165], v[130:131], v[148:149] op_sel_hi:[1,0,1]
  v_pk_fma_f32 v[150:151], v[166:167], v[130:131], v[150:151] op_sel_hi:[1,0,1]
  s_waitcnt vmcnt(4)
  v_lshlrev_b32 v160, 16, v76
  v_and_b32 v161, 0xffff0000, v76
  v_lshlrev_b32 v162, 16, v77
  v_and_b32 v163, 0xffff0000, v77
  v_lshlrev_b32 v164, 16, v78
  v_and_b32 v165, 0xffff0000, v78
  v_lshlrev_b32 v166, 16, v79
  v_and_b32 v167, 0xffff0000, v79
  v_pk_fma_f32 v[136:137], v[160:161], v[122:123], v[136:137] op_sel:[0,1,0] op_sel_hi:[1,1,1]
  v_pk_fma_f32 v[138:139], v[162:163], v[122:123], v[138:139] op_sel:[0,1,0] op_sel_hi:[1,1,1]
  v_pk_fma_f32 v[140:141], v[164:165], v[122:123], v[140:141] op_sel:[0,1,0] op_sel_hi:[1,1,1]
  v_pk_fma_f32 v[142:143], v[166:167], v[122:123], v[142:143] op_sel:[0,1,0] op_sel_hi:[1,1,1]
  v_pk_fma_f32 v[144:145], v[160:161], v[130:131], v[144:145] op_sel:[0,1,0] op_sel_hi:[1,1,1]
  v_pk_fma_f32 v[146:147], v[162:163], v[130:131], v[146:147] op_sel:[0,1,0] op_sel_hi:[1,1,1]
  v_pk_fma_f32 v[148:149], v[164:165], v[130:131], v[148:149] op_sel:[0,1,0] op_sel_hi:[1,1,1]
  v_pk_fma_f32 v[150:151], v[166:167], v[130:131], v[150:151] op_sel:[0,1,0] op_sel_hi:[1,1,1]
  s_waitcnt vmcnt(3)
  v_lshlrev_b32 v160, 16, v80
  v_and_b32 v161, 0xffff0000, v80
  v_lshlrev_b32 v162, 16, v81
  v_and_b32 v163, 0xffff0000, v81
  v_lshlrev_b32 v164, 16, v82
  v_and_b32 v165, 0xffff0000, v82
  v_lshlrev_b32 v166, 16, v83
  v_and_b32 v167, 0xffff0000, v83
  v_pk_fma_f32 v[136:137], v[160:161], v[124:125], v[136:137] op_sel_hi:[1,0,1]
  v_pk_fma_f32 v[138:139], v[162:163], v[124:125], v[138:139] op_sel_hi:[1,0,1]
  v_pk_fma_f32 v[140:141], v[164:165], v[124:125], v[140:141] op_sel_hi:[1,0,1]
  v_pk_fma_f32 v[142:143], v[166:167], v[124:125], v[142:143] op_sel_hi:[1,0,1]
  v_pk_fma_f32 v[144:145], v[160:161], v[132:133], v[144:145] op_sel_hi:[1,0,1]
  v_pk_fma_f32 v[146:147], v[162:163], v[132:133], v[146:147] op_sel_hi:[1,0,1]
  v_pk_fma_f32 v[148:149], v[164:165], v[132:133], v[148:149] op_sel_hi:[1,0,1]
  v_pk_fma_f32 v[150:151], v[166:167], v[132:133], v[150:151] op_sel_hi:[1,0,1]
  s_waitcnt vmcnt(2)
  v_lshlrev_b32 v160, 16, v84
  v_and_b32 v161, 0xffff0000, v84
  v_lshlrev_b32 v162, 16, v85
  v_and_b32 v163, 0xffff0000, v85
  v_lshlrev_b32 v164, 16, v86
  v_and_b32 v165, 0xffff0000, v86
  v_lshlrev_b32 v166, 16, v87
  v_and_b32 v167, 0xffff0000, v87
  v_pk_fma_f32 v[136:137], v[160:161], v[124:125], v[136:137] op_sel:[0,1,0] op_sel_hi:[1,1,1]
  v_pk_fma_f32 v[138:139], v[162:163], v[124:125], v[138:139] op_sel:[0,1,0] op_sel_hi:[1,1,1]
  v_pk_fma_f32 v[140:141], v[164:165], v[124:125], v[140:141] op_sel:[0,1,0] op_sel_hi:[1,1,1]
  v_pk_fma_f32 v[142:143], v[166:167], v[124:125], v[142:143] op_sel:[0,1,0] op_sel_hi:[1,1,1]
  v_pk_fma_f32 v[144:145], v[160:161], v[132:133], v[144:145] op_sel:[0,1,0] op_sel_hi:[1,1,1]
  v_pk_fma_f32 v[146:147], v[162:163], v[132:133], v[146:147] op_sel:[0,1,0] op_sel_hi:[1,1,1]
  v_pk_fma_f32 v[148:149], v[164:165], v[132:133], v[148:149] op_sel:[0,1,0] op_sel_hi:[1,1,1]
  v_pk_fma_f32 v[150:151], v[166:167], v[132:133], v[150:151] op_sel:[0,1,0] op_sel_hi:[1,1,1]
  s_waitcnt vmcnt(1)
  v_lshlrev_b32 v160, 16, v88
  v_and_b32 v161, 0xffff0000, v88
  v_lshlrev_b32 v162, 16, v89
  v_and_b32 v163, 0xffff0000, v89
  v_lshlrev_b32 v164, 16, v90
  v_and_b32 v165, 0xffff0000, v90
  v_lshlrev_b32 v166, 16, v91
  v_and_b32 v167, 0xffff0000, v91
  v_pk_fma_f32 v[136:137], v[160:161], v[126:127], v[136:137] op_sel_hi:[1,0,1]
  v_pk_fma_f32 v[138:139], v[162:163], v[126:127], v[138:139] op_sel_hi:[1,0,1]
  v_pk_fma_f32 v[140:141], v[164:165], v[126:127], v[140:141] op_sel_hi:[1,0,1]
  v_pk_fma_f32 v[142:143], v[166:167], v[126:127], v[142:143] op_sel_hi:[1,0,1]
  v_pk_fma_f32 v[144:145], v[160:161], v[134:135], v[144:145] op_sel_hi:[1,0,1]
  v_pk_fma_f32 v[146:147], v[162:163], v[134:135], v[146:147] op_sel_hi:[1,0,1]
  v_pk_fma_f32 v[148:149], v[164:165], v[134:135], v[148:149] op_sel_hi:[1,0,1]
  v_pk_fma_f32 v[150:151], v[166:167], v[134:135], v[150:151] op_sel_hi:[1,0,1]
  s_waitcnt vmcnt(0)
  v_lshlrev_b32 v160, 16, v92
  v_and_b32 v161, 0xffff0000, v92
  v_lshlrev_b32 v162, 16, v93
  v_and_b32 v163, 0xffff0000, v93
  v_lshlrev_b32 v164, 16, v94
  v_and_b32 v165, 0xffff0000, v94
  v_lshlrev_b32 v166, 16, v95
  v_and_b32 v167, 0xffff0000, v95
  v_pk_fma_f32 v[136:137], v[160:161], v[126:127], v[136:137] op_sel:[0,1,0] op_sel_hi:[1,1,1]
  v_pk_fma_f32 v[138:139], v[162:163], v[126:127], v[138:139] op_sel:[0,1,0] op_sel_hi:[1,1,1]
  v_pk_fma_f32 v[140:141], v[164:165], v[126:127], v[140:141] op_sel:[0,1,0] op_sel_hi:[1,1,1]
  v_pk_fma_f32 v[142:143], v[166:167], v[126:127], v[142:143] op_sel:[0,1,0] op_sel_hi:[1,1,1]
  v_pk_fma_f32 v[144:145], v[160:161], v[134:135], v[144:145] op_sel:[0,1,0] op_sel_hi:[1,1,1]
  v_pk_fma_f32 v[146:147], v[162:163], v[134:135], v[146:147] op_sel:[0,1,0] op_sel_hi:[1,1,1]
  v_pk_fma_f32 v[148:149], v[164:165], v[134:135], v[148:149] op_sel:[0,1,0] op_sel_hi:[1,1,1]
  v_pk_fma_f32 v[150:151], v[166:167], v[134:135], v[150:151] op_sel:[0,1,0] op_sel_hi:[1,1,1]
  v_lshrrev_b32 v3, 4, v0
  v_lshlrev_b32 v3, 10, v3
  v_and_b32 v5, 15, v0
  v_lshlrev_b32 v5, 5, v5
  v_add_u32 v3, v3, v5
  ds_write_b128 v3, v[136:139]
  ds_write_b128 v3, v[140:143] offset:16
  ds_write_b128 v3, v[144:147] offset:512
  ds_write_b128 v3, v[148:151] offset:528
  v_mov_b32 v160, v152
  v_mov_b32 v161, v155
  v_mov_b32 v162, v153
  v_mov_b32 v163, v156
  v_lshlrev_b32 v5, 4, v2
  v_cmp_eq_u32 vcc, 0, v1
  s_and_saveexec_b64 s[36:37], vcc
  ds_write_b128 v5, v[160:163] offset:32768
  s_mov_b64 exec, s[36:37]
  s_waitcnt lgkmcnt(0)
  s_barrier
  v_cmp_gt_u32 vcc, 256, v0
  s_and_saveexec_b64 s[36:37], vcc
  s_cbranch_execz K2_END
  v_lshrrev_b32 v3, 7, v0
  v_lshlrev_b32 v3, 3, v3
  ds_read_b64 v[32:33], v3 offset:32768
  ds_read_b64 v[34:35], v3 offset:32784
  ds_read_b64 v[36:37], v3 offset:32800
  ds_read_b64 v[38:39], v3 offset:32816
  ds_read_b64 v[40:41], v3 offset:32832
  ds_read_b64 v[42:43], v3 offset:32848
  ds_read_b64 v[44:45], v3 offset:32864
  ds_read_b64 v[46:47], v3 offset:32880
  v_lshlrev_b32 v4, 2, v0
  ds_read_b32 v64, v4 offset:0
  ds_read_b32 v65, v4 offset:1024
  ds_read_b32 v66, v4 offset:2048
  ds_read_b32 v67, v4 offset:3072
  ds_read_b32 v68, v4 offset:4096
  ds_read_b32 v69, v4 offset:5120
  ds_read_b32 v70, v4 offset:6144
  ds_read_b32 v71, v4 offset:7168
  ds_read_b32 v72, v4 offset:8192
  ds_read_b32 v73, v4 offset:9216
  ds_read_b32 v74, v4 offset:10240
  ds_read_b32 v75, v4 offset:11264
  ds_read_b32 v76, v4 offset:12288
  ds_read_b32 v77, v4 offset:13312
  ds_read_b32 v78, v4 offset:14336
  ds_read_b32 v79, v4 offset:15360
  ds_read_b32 v80, v4 offset:16384
  ds_read_b32 v81, v4 offset:17408
  ds_read_b32 v82, v4 offset:18432
  ds_read_b32 v83, v4 offset:19456
  ds_read_b32 v84, v4 offset:20480
  ds_read_b32 v85, v4 offset:21504
  ds_read_b32 v86, v4 offset:22528
  ds_read_b32 v87, v4 offset:23552
  ds_read_b32 v88, v4 offset:24576
  ds_read_b32 v89, v4 offset:25600
  ds_read_b32 v90, v4 offset:26624
  ds_read_b32 v91, v4 offset:27648
  ds_read_b32 v92, v4 offset:28672
  ds_read_b32 v93, v4 offset:29696
  ds_read_b32 v94, v4 offset:30720
  ds_read_b32 v95, v4 offset:31744
  s_waitcnt lgkmcnt(0)
  v_max3_f32 v5, v32, v34, v36
  v_max3_f32 v5, v5, v38, v40
  v_max3_f32 v5, v5, v42, v44
  v_max_f32 v5, v5, v46
  v_mov_b32 v6, 0
  v_mov_b32 v7, 0
  v_sub_f32 v8, v32, v5
  v_mul_f32 v8, v154, v8
  v_exp_f32 v8, v8
  v_add_f32 v9, v64, v65
  v_add_f32 v10, v66, v67
  v_add_f32 v9, v9, v10
  v_fmac_f32 v6, v8, v33
  v_fmac_f32 v7, v8, v9
  v_sub_f32 v8, v34, v5
  v_mul_f32 v8, v154, v8
  v_exp_f32 v8, v8
  v_add_f32 v9, v68, v69
  v_add_f32 v10, v70, v71
  v_add_f32 v9, v9, v10
  v_fmac_f32 v6, v8, v35
  v_fmac_f32 v7, v8, v9
  v_sub_f32 v8, v36, v5
  v_mul_f32 v8, v154, v8
  v_exp_f32 v8, v8
  v_add_f32 v9, v72, v73
  v_add_f32 v10, v74, v75
  v_add_f32 v9, v9, v10
  v_fmac_f32 v6, v8, v37
  v_fmac_f32 v7, v8, v9
  v_sub_f32 v8, v38, v5
  v_mul_f32 v8, v154, v8
  v_exp_f32 v8, v8
  v_add_f32 v9, v76, v77
  v_add_f32 v10, v78, v79
  v_add_f32 v9, v9, v10
  v_fmac_f32 v6, v8, v39
  v_fmac_f32 v7, v8, v9
  v_sub_f32 v8, v40, v5
  v_mul_f32 v8, v154, v8
  v_exp_f32 v8, v8
  v_add_f32 v9, v80, v81
  v_add_f32 v10, v82, v83
  v_add_f32 v9, v9, v10
  v_fmac_f32 v6, v8, v41
  v_fmac_f32 v7, v8, v9
  v_sub_f32 v8, v42, v5
  v_mul_f32 v8, v154, v8
  v_exp_f32 v8, v8
  v_add_f32 v9, v84, v85
  v_add_f32 v10, v86, v87
  v_add_f32 v9, v9, v10
  v_fmac_f32 v6, v8, v43
  v_fmac_f32 v7, v8, v9
  v_sub_f32 v8, v44, v5
  v_mul_f32 v8, v154, v8
  v_exp_f32 v8, v8
  v_add_f32 v9, v88, v89
  v_add_f32 v10, v90, v91
  v_add_f32 v9, v9, v10
  v_fmac_f32 v6, v8, v45
  v_fmac_f32 v7, v8, v9
  v_sub_f32 v8, v46, v5
  v_mul_f32 v8, v154, v8
  v_exp_f32 v8, v8
  v_add_f32 v9, v92, v93
  v_add_f32 v10, v94, v95
  v_add_f32 v9, v9, v10
  v_fmac_f32 v6, v8, v47
  v_fmac_f32 v7, v8, v9
  v_lshrrev_b32 v3, 7, v0
  v_lshlrev_b32 v3, 13, v3
  v_and_b32 v4, 127, v0
  v_lshlrev_b32 v8, 2, v4
  v_add_u32 v3, v3, v8
  s_lshl_b32 s34, s30, 14
  s_lshl_b32 s35, s31, 9
  s_add_u32 s34, s34, s35
  s_add_u32 s34, s34, 65536
  buffer_store_dword v7, v3, s[20:23], s34 offen
  v_cmp_eq_u32 vcc, 0, v4
  s_and_saveexec_b64 s[36:37], vcc
  v_lshrrev_b32 v3, 7, v0
  v_lshlrev_b32 v3, 7, v3
  s_lshl_b32 s34, s30, 8
  s_lshl_b32 s35, s31, 3
  s_add_u32 s34, s34, s35
  s_add_u32 s34, s34, 524288
  v_mov_b32 v10, v5
  v_mov_b32 v11, v6
  buffer_store_dwordx2 v[10:11], v3, s[20:23], s34 offen
K2_END:
  s_endpgm
.section .rodata,"a"
.p2align 6
.amdhsa_kernel k2_attn_kernel
  .amdhsa_next_free_vgpr 168
  .amdhsa_next_free_sgpr 48
  .amdhsa_accum_offset 168
  .amdhsa_group_segment_fixed_size 0
  .amdhsa_kernarg_size 104
  .amdhsa_user_sgpr_count 2
  .amdhsa_user_sgpr_kernarg_segment_ptr 1
  .amdhsa_system_sgpr_workgroup_id_x 1
.end_amdhsa_kernel
.text
.globl k3_wo_kernel
.p2align 8
.type k3_wo_kernel,@function
k3_wo_kernel:
  s_cmp_ge_u32 s2, 256
  s_cbranch_scc1 K3_END
  s_load_dwordx2 s[4:5], s[0:1], 32
  s_load_dwordx2 s[8:9], s[0:1], 96
  s_waitcnt lgkmcnt(0)
  s_mov_b32 s12, s4
  s_and_b32 s13, s5, 0xffff
  s_mov_b32 s14, 4718592
  s_mov_b32 s15, 0x00020000
  s_mov_b32 s20, s8
  s_and_b32 s21, s9, 0xffff
  s_mov_b32 s22, 1073741824
  s_mov_b32 s23, 0x00020000
  s_lshr_b32 s30, s2, 3
  s_and_b32 s31, s2, 7
  s_lshl_b32 s32, s30, 7
  s_lshl_b32 s33, s31, 4
  s_add_u32 s32, s32, s33
  s_mul_i32 s33, s32, 1152
  s_add_u32 s34, s33, 9216
  v_lshlrev_b32 v1, 4, v0
  buffer_load_dwordx4 v[32:35], v1, s[12:15], s33 offen sc1 nt
  buffer_load_dwordx4 v[36:39], v1, s[12:15], s34 offen sc1 nt
  v_mul_u32_u24 v2, 911, v0
  v_lshrrev_b32 v2, 16, v2
  s_lshl_b32 s35, s30, 7
  s_add_u32 s35, s35, 524288
  v_mov_b32 v3, 0
  buffer_load_dwordx4 v[40:43], v3, s[20:23], s35 offen offset:0
  buffer_load_dwordx4 v[44:47], v3, s[20:23], s35 offen offset:16
  buffer_load_dwordx4 v[48:51], v3, s[20:23], s35 offen offset:32
  buffer_load_dwordx4 v[52:55], v3, s[20:23], s35 offen offset:48
  buffer_load_dwordx4 v[56:59], v3, s[20:23], s35 offen offset:64
  buffer_load_dwordx4 v[60:63], v3, s[20:23], s35 offen offset:80
  buffer_load_dwordx4 v[64:67], v3, s[20:23], s35 offen offset:96
  buffer_load_dwordx4 v[68:71], v3, s[20:23], s35 offen offset:112
  s_lshl_b32 s35, s30, 13
  s_lshl_b32 s36, s31, 6
  s_add_u32 s35, s35, s36
  s_add_u32 s35, s35, 65536
  v_lshlrev_b32 v3, 2, v2
  s_add_u32 s37, s35, 4096
  buffer_load_dword v72, v3, s[20:23], s35 offen offset:0
  buffer_load_dword v73, v3, s[20:23], s35 offen offset:512
  buffer_load_dword v74, v3, s[20:23], s35 offen offset:1024
  buffer_load_dword v75, v3, s[20:23], s35 offen offset:1536
  buffer_load_dword v76, v3, s[20:23], s35 offen offset:2048
  buffer_load_dword v77, v3, s[20:23], s35 offen offset:2560
  buffer_load_dword v78, v3, s[20:23], s35 offen offset:3072
  buffer_load_dword v79, v3, s[20:23], s35 offen offset:3584
  buffer_load_dword v80, v3, s[20:23], s37 offen offset:0
  buffer_load_dword v81, v3, s[20:23], s37 offen offset:512
  buffer_load_dword v82, v3, s[20:23], s37 offen offset:1024
  buffer_load_dword v83, v3, s[20:23], s37 offen offset:1536
  buffer_load_dword v84, v3, s[20:23], s37 offen offset:2048
  buffer_load_dword v85, v3, s[20:23], s37 offen offset:2560
  buffer_load_dword v86, v3, s[20:23], s37 offen offset:3072
  buffer_load_dword v87, v3, s[20:23], s37 offen offset:3584
  buffer_load_dword v88, v3, s[20:23], s35 offen offset:32
  buffer_load_dword v89, v3, s[20:23], s35 offen offset:544
  buffer_load_dword v90, v3, s[20:23], s35 offen offset:1056
  buffer_load_dword v91, v3, s[20:23], s35 offen offset:1568
  buffer_load_dword v92, v3, s[20:23], s35 offen offset:2080
  buffer_load_dword v93, v3, s[20:23], s35 offen offset:2592
  buffer_load_dword v94, v3, s[20:23], s35 offen offset:3104
  buffer_load_dword v95, v3, s[20:23], s35 offen offset:3616
  buffer_load_dword v96, v3, s[20:23], s37 offen offset:32
  buffer_load_dword v97, v3, s[20:23], s37 offen offset:544
  buffer_load_dword v98, v3, s[20:23], s37 offen offset:1056
  buffer_load_dword v99, v3, s[20:23], s37 offen offset:1568
  buffer_load_dword v100, v3, s[20:23], s37 offen offset:2080
  buffer_load_dword v101, v3, s[20:23], s37 offen offset:2592
  buffer_load_dword v102, v3, s[20:23], s37 offen offset:3104
  buffer_load_dword v103, v3, s[20:23], s37 offen offset:3616
  s_waitcnt vmcnt(32)
  v_max3_f32 v5, v40, v42, v44
  v_max3_f32 v5, v5, v46, v48
  v_max3_f32 v5, v5, v50, v52
  v_max3_f32 v5, v5, v54, v56
  v_max3_f32 v5, v5, v58, v60
  v_max3_f32 v5, v5, v62, v64
  v_max3_f32 v5, v5, v66, v68
  v_max_f32 v5, v5, v70
  v_mov_b32 v6, 0x3e0293ee
  v_mov_b32 v7, 0
  v_sub_f32 v40, v40, v5
  v_mul_f32 v40, v6, v40
  v_exp_f32 v40, v40
  s_nop 0
  v_fmac_f32 v7, v40, v41
  v_sub_f32 v42, v42, v5
  v_mul_f32 v42, v6, v42
  v_exp_f32 v42, v42
  s_nop 0
  v_fmac_f32 v7, v42, v43
  v_sub_f32 v44, v44, v5
  v_mul_f32 v44, v6, v44
  v_exp_f32 v44, v44
  s_nop 0
  v_fmac_f32 v7, v44, v45
  v_sub_f32 v46, v46, v5
  v_mul_f32 v46, v6, v46
  v_exp_f32 v46, v46
  s_nop 0
  v_fmac_f32 v7, v46, v47
  v_sub_f32 v48, v48, v5
  v_mul_f32 v48, v6, v48
  v_exp_f32 v48, v48
  s_nop 0
  v_fmac_f32 v7, v48, v49
  v_sub_f32 v50, v50, v5
  v_mul_f32 v50, v6, v50
  v_exp_f32 v50, v50
  s_nop 0
  v_fmac_f32 v7, v50, v51
  v_sub_f32 v52, v52, v5
  v_mul_f32 v52, v6, v52
  v_exp_f32 v52, v52
  s_nop 0
  v_fmac_f32 v7, v52, v53
  v_sub_f32 v54, v54, v5
  v_mul_f32 v54, v6, v54
  v_exp_f32 v54, v54
  s_nop 0
  v_fmac_f32 v7, v54, v55
  v_sub_f32 v56, v56, v5
  v_mul_f32 v56, v6, v56
  v_exp_f32 v56, v56
  s_nop 0
  v_fmac_f32 v7, v56, v57
  v_sub_f32 v58, v58, v5
  v_mul_f32 v58, v6, v58
  v_exp_f32 v58, v58
  s_nop 0
  v_fmac_f32 v7, v58, v59
  v_sub_f32 v60, v60, v5
  v_mul_f32 v60, v6, v60
  v_exp_f32 v60, v60
  s_nop 0
  v_fmac_f32 v7, v60, v61
  v_sub_f32 v62, v62, v5
  v_mul_f32 v62, v6, v62
  v_exp_f32 v62, v62
  s_nop 0
  v_fmac_f32 v7, v62, v63
  v_sub_f32 v64, v64, v5
  v_mul_f32 v64, v6, v64
  v_exp_f32 v64, v64
  s_nop 0
  v_fmac_f32 v7, v64, v65
  v_sub_f32 v66, v66, v5
  v_mul_f32 v66, v6, v66
  v_exp_f32 v66, v66
  s_nop 0
  v_fmac_f32 v7, v66, v67
  v_sub_f32 v68, v68, v5
  v_mul_f32 v68, v6, v68
  v_exp_f32 v68, v68
  s_nop 0
  v_fmac_f32 v7, v68, v69
  v_sub_f32 v70, v70, v5
  v_mul_f32 v70, v6, v70
  v_exp_f32 v70, v70
  s_nop 0
  v_fmac_f32 v7, v70, v71
  v_rcp_f32 v7, v7
  s_waitcnt vmcnt(0)
  v_mul_f32 v8, v40, v72
  v_fmac_f32 v8, v42, v73
  v_fmac_f32 v8, v44, v74
  v_fmac_f32 v8, v46, v75
  v_fmac_f32 v8, v48, v76
  v_fmac_f32 v8, v50, v77
  v_fmac_f32 v8, v52, v78
  v_fmac_f32 v8, v54, v79
  v_fmac_f32 v8, v56, v80
  v_fmac_f32 v8, v58, v81
  v_fmac_f32 v8, v60, v82
  v_fmac_f32 v8, v62, v83
  v_fmac_f32 v8, v64, v84
  v_fmac_f32 v8, v66, v85
  v_fmac_f32 v8, v68, v86
  v_fmac_f32 v8, v70, v87
  v_mul_f32 v8, v8, v7
  v_mul_f32 v9, v40, v88
  v_fmac_f32 v9, v42, v89
  v_fmac_f32 v9, v44, v90
  v_fmac_f32 v9, v46, v91
  v_fmac_f32 v9, v48, v92
  v_fmac_f32 v9, v50, v93
  v_fmac_f32 v9, v52, v94
  v_fmac_f32 v9, v54, v95
  v_fmac_f32 v9, v56, v96
  v_fmac_f32 v9, v58, v97
  v_fmac_f32 v9, v60, v98
  v_fmac_f32 v9, v62, v99
  v_fmac_f32 v9, v64, v100
  v_fmac_f32 v9, v66, v101
  v_fmac_f32 v9, v68, v102
  v_fmac_f32 v9, v70, v103
  v_mul_f32 v9, v9, v7
  v_mov_b32 v16, 0
  v_mov_b32 v17, 0
  v_mov_b32 v18, 0
  v_mov_b32 v19, 0
  v_mov_b32 v20, 0
  v_mov_b32 v21, 0
  v_mov_b32 v22, 0
  v_mov_b32 v23, 0
  v_lshlrev_b32 v6, 16, v32
  v_and_b32 v7, 0xffff0000, v32
  v_fmac_f32 v16, v6, v8
  v_fmac_f32 v17, v7, v8
  v_lshlrev_b32 v6, 16, v33
  v_and_b32 v7, 0xffff0000, v33
  v_fmac_f32 v18, v6, v8
  v_fmac_f32 v19, v7, v8
  v_lshlrev_b32 v6, 16, v34
  v_and_b32 v7, 0xffff0000, v34
  v_fmac_f32 v20, v6, v8
  v_fmac_f32 v21, v7, v8
  v_lshlrev_b32 v6, 16, v35
  v_and_b32 v7, 0xffff0000, v35
  v_fmac_f32 v22, v6, v8
  v_fmac_f32 v23, v7, v8
  v_lshlrev_b32 v6, 16, v36
  v_and_b32 v7, 0xffff0000, v36
  v_fmac_f32 v16, v6, v9
  v_fmac_f32 v17, v7, v9
  v_lshlrev_b32 v6, 16, v37
  v_and_b32 v7, 0xffff0000, v37
  v_fmac_f32 v18, v6, v9
  v_fmac_f32 v19, v7, v9
  v_lshlrev_b32 v6, 16, v38
  v_and_b32 v7, 0xffff0000, v38
  v_fmac_f32 v20, v6, v9
  v_fmac_f32 v21, v7, v9
  v_lshlrev_b32 v6, 16, v39
  v_and_b32 v7, 0xffff0000, v39
  v_fmac_f32 v22, v6, v9
  v_fmac_f32 v23, v7, v9
  v_mul_u32_u24 v3, 72, v2
  v_sub_u32 v3, v0, v3
  v_lshlrev_b32 v3, 5, v3
  v_mul_u32_u24 v4, 2304, v2
  v_add_u32 v3, v3, v4
  ds_write_b128 v3, v[16:19]
  ds_write_b128 v3, v[20:23] offset:16
  s_waitcnt lgkmcnt(0)
  s_barrier
  v_lshlrev_b32 v3, 2, v0
  ds_read_b32 v16, v3 offset:0
  ds_read_b32 v17, v3 offset:2304
  ds_read_b32 v18, v3 offset:4608
  ds_read_b32 v19, v3 offset:6912
  ds_read_b32 v20, v3 offset:9216
  ds_read_b32 v21, v3 offset:11520
  ds_read_b32 v22, v3 offset:13824
  ds_read_b32 v23, v3 offset:16128
  s_waitcnt lgkmcnt(0)
  v_add_f32 v16, v16, v17
  v_add_f32 v16, v16, v18
  v_add_f32 v16, v16, v19
  v_add_f32 v16, v16, v20
  v_add_f32 v16, v16, v21
  v_add_f32 v16, v16, v22
  v_add_f32 v16, v16, v23
  s_and_b32 s35, s2, 15
  s_mul_i32 s35, s35, 2304
  s_add_u32 s35, s35, 1048576
  buffer_atomic_add_f32 v16, v3, s[20:23], s35 offen
K3_END:
  s_endpgm
.section .rodata,"a"
.p2align 6
.amdhsa_kernel k3_wo_kernel
  .amdhsa_next_free_vgpr 104
  .amdhsa_next_free_sgpr 48
  .amdhsa_accum_offset 104
  .amdhsa_group_segment_fixed_size 0
  .amdhsa_kernarg_size 104
  .amdhsa_user_sgpr_count 2
  .amdhsa_user_sgpr_kernarg_segment_ptr 1
  .amdhsa_system_sgpr_workgroup_id_x 1
.end_amdhsa_kernel
.text
.globl k4_ffn_kernel
.p2align 8
.type k4_ffn_kernel,@function
k4_ffn_kernel:
  s_cmp_ge_u32 s2, 144
  s_cbranch_scc1 K4_END
  s_load_dwordx2 s[4:5], s[0:1], 0
  s_load_dwordx2 s[6:7], s[0:1], 48
  s_load_dwordx2 s[8:9], s[0:1], 96
  s_load_dwordx2 s[10:11], s[0:1], 56
  s_load_dwordx2 s[28:29], s[0:1], 64
  s_waitcnt lgkmcnt(0)
  s_mov_b32 s12, s4
  s_and_b32 s13, s5, 0xffff
  s_mov_b32 s14, 1152
  s_mov_b32 s15, 0x00020000
  s_mov_b32 s16, s6
  s_and_b32 s17, s7, 0xffff
  s_mov_b32 s18, 5308416
  s_mov_b32 s19, 0x00020000
  s_mov_b32 s20, s8
  s_and_b32 s21, s9, 0xffff
  s_mov_b32 s22, 1073741824
  s_mov_b32 s23, 0x00020000
  s_mov_b32 s24, s10
  s_and_b32 s25, s11, 0xffff
  s_mov_b32 s26, 9216
  s_mov_b32 s27, 0x00020000
  s_mov_b32 s36, s28
  s_and_b32 s37, s29, 0xffff
  s_mov_b32 s38, 5308416
  s_mov_b32 s39, 0x00020000
  s_and_b32 s30, s2, 7
  s_mul_i32 s30, s30, 18
  s_lshr_b32 s31, s2, 3
  s_add_u32 s30, s30, s31
  s_lshl_b32 s31, s30, 6
  v_lshrrev_b32 v2, 2, v0
  v_mul_u32_u24 v3, 9216, v2
  v_and_b32 v4, 3, v0
  v_lshlrev_b32 v4, 4, v4
  v_add_u32 v3, v3, v4
  s_add_u32 s40, s31, 0
  s_add_u32 s41, s31, 1327104
  s_add_u32 s42, s31, 2654208
  s_add_u32 s43, s31, 3981312
  buffer_load_dwordx4 v[32:35], v3, s[16:19], s40 offen sc1 nt
  buffer_load_dwordx4 v[36:39], v3, s[16:19], s41 offen sc1 nt
  buffer_load_dwordx4 v[40:43], v3, s[16:19], s42 offen sc1 nt
  buffer_load_dwordx4 v[44:47], v3, s[16:19], s43 offen sc1 nt
  s_mul_i32 s32, s30, 36864
  v_lshlrev_b32 v1, 4, v0
  s_add_u32 s44, s32, 0
  s_add_u32 s45, s32, 9216
  s_add_u32 s46, s32, 18432
  s_add_u32 s47, s32, 27648
  buffer_load_dwordx4 v[48:51], v1, s[36:39], s44 offen sc1 nt
  buffer_load_dwordx4 v[52:55], v1, s[36:39], s45 offen sc1 nt
  buffer_load_dwordx4 v[56:59], v1, s[36:39], s46 offen sc1 nt
  buffer_load_dwordx4 v[60:63], v1, s[36:39], s47 offen sc1 nt
  v_lshlrev_b32 v4, 1, v0
  buffer_load_ushort v64, v4, s[12:15], 0 offen
  v_lshlrev_b32 v4, 2, v0
  s_mov_b32 s60, 1048576
  s_mov_b32 s61, 1050880
  s_mov_b32 s62, 1053184
  s_mov_b32 s63, 1055488
  s_mov_b32 s64, 1057792
  s_mov_b32 s65, 1060096
  s_mov_b32 s66, 1062400
  s_mov_b32 s67, 1064704
  s_mov_b32 s68, 1067008
  s_mov_b32 s69, 1069312
  s_mov_b32 s70, 1071616
  s_mov_b32 s71, 1073920
  s_mov_b32 s72, 1076224
  s_mov_b32 s73, 1078528
  s_mov_b32 s74, 1080832
  s_mov_b32 s75, 1083136
  buffer_load_dword v65, v4, s[20:23], s60 offen
  buffer_load_dword v66, v4, s[20:23], s61 offen
  buffer_load_dword v67, v4, s[20:23], s62 offen
  buffer_load_dword v68, v4, s[20:23], s63 offen
  buffer_load_dword v69, v4, s[20:23], s64 offen
  buffer_load_dword v70, v4, s[20:23], s65 offen
  buffer_load_dword v71, v4, s[20:23], s66 offen
  buffer_load_dword v72, v4, s[20:23], s67 offen
  buffer_load_dword v73, v4, s[20:23], s68 offen
  buffer_load_dword v74, v4, s[20:23], s69 offen
  buffer_load_dword v75, v4, s[20:23], s70 offen
  buffer_load_dword v76, v4, s[20:23], s71 offen
  buffer_load_dword v77, v4, s[20:23], s72 offen
  buffer_load_dword v78, v4, s[20:23], s73 offen
  buffer_load_dword v79, v4, s[20:23], s74 offen
  buffer_load_dword v80, v4, s[20:23], s75 offen
  s_waitcnt vmcnt(0)
  v_lshlrev_b32 v64, 16, v64
  v_add_f32 v64, v64, v65
  v_add_f32 v64, v64, v66
  v_add_f32 v64, v64, v67
  v_add_f32 v64, v64, v68
  v_add_f32 v64, v64, v69
  v_add_f32 v64, v64, v70
  v_add_f32 v64, v64, v71
  v_add_f32 v64, v64, v72
  v_add_f32 v64, v64, v73
  v_add_f32 v64, v64, v74
  v_add_f32 v64, v64, v75
  v_add_f32 v64, v64, v76
  v_add_f32 v64, v64, v77
  v_add_f32 v64, v64, v78
  v_add_f32 v64, v64, v79
  v_add_f32 v64, v64, v80
  ds_write_b32 v4, v64 offset:20480
  s_cmp_lg_u32 s2, 0
  s_cbranch_scc1 K4_NOH
  s_mov_b32 s33, 1122304
  buffer_store_dword v64, v4, s[20:23], s33 offen
K4_NOH:
  s_waitcnt lgkmcnt(0)
  s_barrier
  v_and_b32 v5, 63, v0
  v_lshlrev_b32 v5, 2, v5
  ds_read_b32 v65, v5 offset:20480
  ds_read_b32 v66, v5 offset:20736
  ds_read_b32 v67, v5 offset:20992
  ds_read_b32 v68, v5 offset:21248
  ds_read_b32 v69, v5 offset:21504
  ds_read_b32 v70, v5 offset:21760
  ds_read_b32 v71, v5 offset:22016
  ds_read_b32 v72, v5 offset:22272
  ds_read_b32 v73, v5 offset:22528
  v_lshlrev_b32 v5, 2, v2
  ds_read_b32 v76, v5 offset:20480
  ds_read_b32 v77, v5 offset:21056
  ds_read_b32 v78, v5 offset:21632
  ds_read_b32 v79, v5 offset:22208
  s_waitcnt lgkmcnt(0)
  v_add_f32 v6, v65, v66
  v_add_f32 v6, v6, v67
  v_add_f32 v6, v6, v68
  v_add_f32 v6, v6, v69
  v_add_f32 v6, v6, v70
  v_add_f32 v6, v6, v71
  v_add_f32 v6, v6, v72
  v_add_f32 v6, v6, v73
  s_nop 1
  v_add_f32_dpp v7, v6, v6 quad_perm:[1,0,3,2] row_mask:0xf bank_mask:0xf
  s_nop 1
  v_add_f32_dpp v6, v7, v7 quad_perm:[2,3,0,1] row_mask:0xf bank_mask:0xf
  s_nop 1
  v_add_f32_dpp v7, v6, v6 row_half_mirror row_mask:0xf bank_mask:0xf
  s_nop 1
  v_add_f32_dpp v6, v7, v7 row_mirror row_mask:0xf bank_mask:0xf
  s_nop 1
  v_readlane_b32 s48, v6, 0
  v_readlane_b32 s49, v6, 16
  v_readlane_b32 s50, v6, 32
  v_readlane_b32 s51, v6, 48
  s_nop 1
  v_mov_b32 v6, s48
  v_add_f32 v6, s49, v6
  v_add_f32 v6, s50, v6
  v_add_f32 v6, s51, v6
  v_mul_f32 v8, 0x3ae38e39, v6
  v_sub_f32 v7, v65, v8
  v_mul_f32 v6, v7, v7
  v_sub_f32 v7, v66, v8
  v_fmac_f32 v6, v7, v7
  v_sub_f32 v7, v67, v8
  v_fmac_f32 v6, v7, v7
  v_sub_f32 v7, v68, v8
  v_fmac_f32 v6, v7, v7
  v_sub_f32 v7, v69, v8
  v_fmac_f32 v6, v7, v7
  v_sub_f32 v7, v70, v8
  v_fmac_f32 v6, v7, v7
  v_sub_f32 v7, v71, v8
  v_fmac_f32 v6, v7, v7
  v_sub_f32 v7, v72, v8
  v_fmac_f32 v6, v7, v7
  v_sub_f32 v7, v73, v8
  v_fmac_f32 v6, v7, v7
  s_nop 1
  v_add_f32_dpp v7, v6, v6 quad_perm:[1,0,3,2] row_mask:0xf bank_mask:0xf
  s_nop 1
  v_add_f32_dpp v6, v7, v7 quad_perm:[2,3,0,1] row_mask:0xf bank_mask:0xf
  s_nop 1
  v_add_f32_dpp v7, v6, v6 row_half_mirror row_mask:0xf bank_mask:0xf
  s_nop 1
  v_add_f32_dpp v6, v7, v7 row_mirror row_mask:0xf bank_mask:0xf
  s_nop 1
  v_readlane_b32 s48, v6, 0
  v_readlane_b32 s49, v6, 16
  v_readlane_b32 s50, v6, 32
  v_readlane_b32 s51, v6, 48
  s_nop 1
  v_mov_b32 v6, s48
  v_add_f32 v6, s49, v6
  v_add_f32 v6, s50, v6
  v_add_f32 v6, s51, v6
  v_mov_b32 v7, 0x3727c5ac
  v_fmac_f32 v7, 0x3ae38e39, v6
  v_rsq_f32 v9, v7
  s_nop 1
  v_sub_f32 v76, v76, v8
  v_mul_f32 v76, v76, v9
  v_sub_f32 v77, v77, v8
  v_mul_f32 v77, v77, v9
  v_sub_f32 v78, v78, v8
  v_mul_f32 v78, v78, v9
  v_sub_f32 v79, v79, v8
  v_mul_f32 v79, v79, v9
  v_mov_b32 v80, 0
  v_mov_b32 v81, 0
  v_mov_b32 v82, 0
  v_mov_b32 v83, 0
  v_mov_b32 v84, 0
  v_mov_b32 v85, 0
  v_mov_b32 v86, 0
  v_mov_b32 v87, 0
  v_lshlrev_b32 v6, 16, v32
  v_and_b32 v7, 0xffff0000, v32
  v_fmac_f32 v80, v6, v76
  v_fmac_f32 v81, v7, v76
  v_lshlrev_b32 v6, 16, v33
  v_and_b32 v7, 0xffff0000, v33
  v_fmac_f32 v82, v6, v76
  v_fmac_f32 v83, v7, v76
  v_lshlrev_b32 v6, 16, v34
  v_and_b32 v7, 0xffff0000, v34
  v_fmac_f32 v84, v6, v76
  v_fmac_f32 v85, v7, v76
  v_lshlrev_b32 v6, 16, v35
  v_and_b32 v7, 0xffff0000, v35
  v_fmac_f32 v86, v6, v76
  v_fmac_f32 v87, v7, v76
  v_lshlrev_b32 v6, 16, v36
  v_and_b32 v7, 0xffff0000, v36
  v_fmac_f32 v80, v6, v77
  v_fmac_f32 v81, v7, v77
  v_lshlrev_b32 v6, 16, v37
  v_and_b32 v7, 0xffff0000, v37
  v_fmac_f32 v82, v6, v77
  v_fmac_f32 v83, v7, v77
  v_lshlrev_b32 v6, 16, v38
  v_and_b32 v7, 0xffff0000, v38
  v_fmac_f32 v84, v6, v77
  v_fmac_f32 v85, v7, v77
  v_lshlrev_b32 v6, 16, v39
  v_and_b32 v7, 0xffff0000, v39
  v_fmac_f32 v86, v6, v77
  v_fmac_f32 v87, v7, v77
  v_lshlrev_b32 v6, 16, v40
  v_and_b32 v7, 0xffff0000, v40
  v_fmac_f32 v80, v6, v78
  v_fmac_f32 v81, v7, v78
  v_lshlrev_b32 v6, 16, v41
  v_and_b32 v7, 0xffff0000, v41
  v_fmac_f32 v82, v6, v78
  v_fmac_f32 v83, v7, v78
  v_lshlrev_b32 v6, 16, v42
  v_and_b32 v7, 0xffff0000, v42
  v_fmac_f32 v84, v6, v78
  v_fmac_f32 v85, v7, v78
  v_lshlrev_b32 v6, 16, v43
  v_and_b32 v7, 0xffff0000, v43
  v_fmac_f32 v86, v6, v78
  v_fmac_f32 v87, v7, v78
  v_lshlrev_b32 v6, 16, v44
  v_and_b32 v7, 0xffff0000, v44
  v_fmac_f32 v80, v6, v79
  v_fmac_f32 v81, v7, v79
  v_lshlrev_b32 v6, 16, v45
  v_and_b32 v7, 0xffff0000, v45
  v_fmac_f32 v82, v6, v79
  v_fmac_f32 v83, v7, v79
  v_lshlrev_b32 v6, 16, v46
  v_and_b32 v7, 0xffff0000, v46
  v_fmac_f32 v84, v6, v79
  v_fmac_f32 v85, v7, v79
  v_lshlrev_b32 v6, 16, v47
  v_and_b32 v7, 0xffff0000, v47
  v_fmac_f32 v86, v6, v79
  v_fmac_f32 v87, v7, v79
  v_lshlrev_b32 v3, 7, v2
  v_and_b32 v4, 3, v0
  v_lshlrev_b32 v4, 5, v4
  v_add_u32 v3, v3, v4
  ds_write_b128 v3, v[80:83]
  ds_write_b128 v3, v[84:87] offset:16
  s_waitcnt lgkmcnt(0)
  s_barrier
  v_lshrrev_b32 v3, 5, v0
  v_lshlrev_b32 v3, 10, v3
  v_and_b32 v4, 31, v0
  v_lshlrev_b32 v4, 2, v4
  v_add_u32 v3, v3, v4
  ds_read_b32 v80, v3 offset:0
  ds_read_b32 v81, v3 offset:128
  ds_read_b32 v82, v3 offset:256
  ds_read_b32 v83, v3 offset:384
  ds_read_b32 v84, v3 offset:512
  ds_read_b32 v85, v3 offset:640
  ds_read_b32 v86, v3 offset:768
  ds_read_b32 v87, v3 offset:896
  s_waitcnt lgkmcnt(0)
  v_add_f32 v80, v80, v81
  v_add_f32 v80, v80, v82
  v_add_f32 v80, v80, v83
  v_add_f32 v80, v80, v84
  v_add_f32 v80, v80, v85
  v_add_f32 v80, v80, v86
  v_add_f32 v80, v80, v87
  v_lshlrev_b32 v3, 2, v0
  ds_write_b32 v3, v80 offset:18432
  s_waitcnt lgkmcnt(0)
  s_barrier
  ds_read_b32 v80, v4 offset:18432
  ds_read_b32 v81, v4 offset:18560
  ds_read_b32 v82, v4 offset:18688
  ds_read_b32 v83, v4 offset:18816
  ds_read_b32 v84, v4 offset:18944
  ds_read_b32 v85, v4 offset:19072
  ds_read_b32 v86, v4 offset:19200
  ds_read_b32 v87, v4 offset:19328
  ds_read_b32 v88, v4 offset:19456
  ds_read_b32 v89, v4 offset:19584
  ds_read_b32 v90, v4 offset:19712
  ds_read_b32 v91, v4 offset:19840
  ds_read_b32 v92, v4 offset:19968
  ds_read_b32 v93, v4 offset:20096
  ds_read_b32 v94, v4 offset:20224
  ds_read_b32 v95, v4 offset:20352
  ds_read_b32 v96, v4 offset:20480
  ds_read_b32 v97, v4 offset:20608
  v_lshlrev_b32 v5, 1, v0
  v_and_b32 v5, 63, v5
  buffer_load_ushort v100, v5, s[24:27], s31 offen
  s_waitcnt vmcnt(0) lgkmcnt(0)
  v_add_f32 v80, v80, v81
  v_add_f32 v80, v80, v82
  v_add_f32 v80, v80, v83
  v_add_f32 v80, v80, v84
  v_add_f32 v80, v80, v85
  v_add_f32 v80, v80, v86
  v_add_f32 v80, v80, v87
  v_add_f32 v80, v80, v88
  v_add_f32 v80, v80, v89
  v_add_f32 v80, v80, v90
  v_add_f32 v80, v80, v91
  v_add_f32 v80, v80, v92
  v_add_f32 v80, v80, v93
  v_add_f32 v80, v80, v94
  v_add_f32 v80, v80, v95
  v_add_f32 v80, v80, v96
  v_add_f32 v80, v80, v97
  v_lshlrev_b32 v100, 16, v100
  v_add_f32 v80, v80, v100
  v_max_f32 v80, 0, v80
  v_mul_f32 v80, v80, v80
  s_barrier
  ds_write_b32 v4, v80 offset:22800
  s_waitcnt lgkmcnt(0)
  s_barrier
  v_mul_u32_u24 v2, 911, v0
  v_lshrrev_b32 v2, 16, v2
  v_lshlrev_b32 v5, 2, v2
  ds_read_b32 v76, v5 offset:22800
  ds_read_b32 v77, v5 offset:22832
  ds_read_b32 v78, v5 offset:22864
  ds_read_b32 v79, v5 offset:22896
  v_mov_b32 v80, 0
  v_mov_b32 v81, 0
  v_mov_b32 v82, 0
  v_mov_b32 v83, 0
  v_mov_b32 v84, 0
  v_mov_b32 v85, 0
  v_mov_b32 v86, 0
  v_mov_b32 v87, 0
  s_waitcnt lgkmcnt(0)
  v_lshlrev_b32 v6, 16, v48
  v_and_b32 v7, 0xffff0000, v48
  v_fmac_f32 v80, v6, v76
  v_fmac_f32 v81, v7, v76
  v_lshlrev_b32 v6, 16, v49
  v_and_b32 v7, 0xffff0000, v49
  v_fmac_f32 v82, v6, v76
  v_fmac_f32 v83, v7, v76
  v_lshlrev_b32 v6, 16, v50
  v_and_b32 v7, 0xffff0000, v50
  v_fmac_f32 v84, v6, v76
  v_fmac_f32 v85, v7, v76
  v_lshlrev_b32 v6, 16, v51
  v_and_b32 v7, 0xffff0000, v51
  v_fmac_f32 v86, v6, v76
  v_fmac_f32 v87, v7, v76
  v_lshlrev_b32 v6, 16, v52
  v_and_b32 v7, 0xffff0000, v52
  v_fmac_f32 v80, v6, v77
  v_fmac_f32 v81, v7, v77
  v_lshlrev_b32 v6, 16, v53
  v_and_b32 v7, 0xffff0000, v53
  v_fmac_f32 v82, v6, v77
  v_fmac_f32 v83, v7, v77
  v_lshlrev_b32 v6, 16, v54
  v_and_b32 v7, 0xffff0000, v54
  v_fmac_f32 v84, v6, v77
  v_fmac_f32 v85, v7, v77
  v_lshlrev_b32 v6, 16, v55
  v_and_b32 v7, 0xffff0000, v55
  v_fmac_f32 v86, v6, v77
  v_fmac_f32 v87, v7, v77
  v_lshlrev_b32 v6, 16, v56
  v_and_b32 v7, 0xffff0000, v56
  v_fmac_f32 v80, v6, v78
  v_fmac_f32 v81, v7, v78
  v_lshlrev_b32 v6, 16, v57
  v_and_b32 v7, 0xffff0000, v57
  v_fmac_f32 v82, v6, v78
  v_fmac_f32 v83, v7, v78
  v_lshlrev_b32 v6, 16, v58
  v_and_b32 v7, 0xffff0000, v58
  v_fmac_f32 v84, v6, v78
  v_fmac_f32 v85, v7, v78
  v_lshlrev_b32 v6, 16, v59
  v_and_b32 v7, 0xffff0000, v59
  v_fmac_f32 v86, v6, v78
  v_fmac_f32 v87, v7, v78
  v_lshlrev_b32 v6, 16, v60
  v_and_b32 v7, 0xffff0000, v60
  v_fmac_f32 v80, v6, v79
  v_fmac_f32 v81, v7, v79
  v_lshlrev_b32 v6, 16, v61
  v_and_b32 v7, 0xffff0000, v61
  v_fmac_f32 v82, v6, v79
  v_fmac_f32 v83, v7, v79
  v_lshlrev_b32 v6, 16, v62
  v_and_b32 v7, 0xffff0000, v62
  v_fmac_f32 v84, v6, v79
  v_fmac_f32 v85, v7, v79
  v_lshlrev_b32 v6, 16, v63
  v_and_b32 v7, 0xffff0000, v63
  v_fmac_f32 v86, v6, v79
  v_fmac_f32 v87, v7, v79
  v_mul_u32_u24 v3, 72, v2
  v_sub_u32 v3, v0, v3
  v_lshlrev_b32 v3, 5, v3
  v_mul_u32_u24 v4, 2304, v2
  v_add_u32 v3, v3, v4
  ds_write_b128 v3, v[80:83]
  ds_write_b128 v3, v[84:87] offset:16
  s_waitcnt lgkmcnt(0)
  s_barrier
  v_lshlrev_b32 v3, 2, v0
  ds_read_b32 v16, v3 offset:0
  ds_read_b32 v17, v3 offset:2304
  ds_read_b32 v18, v3 offset:4608
  ds_read_b32 v19, v3 offset:6912
  ds_read_b32 v20, v3 offset:9216
  ds_read_b32 v21, v3 offset:11520
  ds_read_b32 v22, v3 offset:13824
  ds_read_b32 v23, v3 offset:16128
  s_waitcnt lgkmcnt(0)
  v_add_f32 v16, v16, v17
  v_add_f32 v16, v16, v18
  v_add_f32 v16, v16, v19
  v_add_f32 v16, v16, v20
  v_add_f32 v16, v16, v21
  v_add_f32 v16, v16, v22
  v_add_f32 v16, v16, v23
  s_and_b32 s35, s2, 15
  s_mul_i32 s35, s35, 2304
  s_add_u32 s35, s35, 1085440
  buffer_atomic_add_f32 v16, v3, s[20:23], s35 offen
K4_END:
  s_endpgm
.section .rodata,"a"
.p2align 6
.amdhsa_kernel k4_ffn_kernel
  .amdhsa_next_free_vgpr 104
  .amdhsa_next_free_sgpr 80
  .amdhsa_accum_offset 104
  .amdhsa_group_segment_fixed_size 0
  .amdhsa_kernarg_size 104
  .amdhsa_user_sgpr_count 2
  .amdhsa_user_sgpr_kernarg_segment_ptr 1
  .amdhsa_system_sgpr_workgroup_id_x 1
.end_amdhsa_kernel
.text
.globl k5_fin_kernel
.p2align 8
.type k5_fin_kernel,@function
k5_fin_kernel:
  s_cmp_ge_u32 s2, 1
  s_cbranch_scc1 K5_END
  s_load_dwordx2 s[4:5], s[0:1], 72
  s_load_dwordx2 s[6:7], s[0:1], 80
  s_load_dwordx2 s[8:9], s[0:1], 96
  s_waitcnt lgkmcnt(0)
  s_mov_b32 s12, s4
  s_and_b32 s13, s5, 0xffff
  s_mov_b32 s14, 1152
  s_mov_b32 s15, 0x00020000
  s_mov_b32 s16, s6
  s_and_b32 s17, s7, 0xffff
  s_mov_b32 s18, 1152
  s_mov_b32 s19, 0x00020000
  s_mov_b32 s20, s8
  s_and_b32 s21, s9, 0xffff
  s_mov_b32 s22, 1073741824
  s_mov_b32 s23, 0x00020000
  v_lshlrev_b32 v1, 1, v0
  v_lshlrev_b32 v2, 2, v0
  buffer_load_ushort v3, v1, s[12:15], 0 offen
  s_mov_b32 s33, 1122304
  buffer_load_dword v4, v2, s[20:23], s33 offen
  s_mov_b32 s60, 1085440
  s_mov_b32 s61, 1087744
  s_mov_b32 s62, 1090048
  s_mov_b32 s63, 1092352
  s_mov_b32 s64, 1094656
  s_mov_b32 s65, 1096960
  s_mov_b32 s66, 1099264
  s_mov_b32 s67, 1101568
  s_mov_b32 s68, 1103872
  s_mov_b32 s69, 1106176
  s_mov_b32 s70, 1108480
  s_mov_b32 s71, 1110784
  s_mov_b32 s72, 1113088
  s_mov_b32 s73, 1115392
  s_mov_b32 s74, 1117696
  s_mov_b32 s75, 1120000
  buffer_load_dword v5, v2, s[20:23], s60 offen
  buffer_load_dword v6, v2, s[20:23], s61 offen
  buffer_load_dword v7, v2, s[20:23], s62 offen
  buffer_load_dword v8, v2, s[20:23], s63 offen
  buffer_load_dword v9, v2, s[20:23], s64 offen
  buffer_load_dword v10, v2, s[20:23], s65 offen
  buffer_load_dword v11, v2, s[20:23], s66 offen
  buffer_load_dword v12, v2, s[20:23], s67 offen
  buffer_load_dword v13, v2, s[20:23], s68 offen
  buffer_load_dword v14, v2, s[20:23], s69 offen
  buffer_load_dword v15, v2, s[20:23], s70 offen
  buffer_load_dword v16, v2, s[20:23], s71 offen
  buffer_load_dword v17, v2, s[20:23], s72 offen
  buffer_load_dword v18, v2, s[20:23], s73 offen
  buffer_load_dword v19, v2, s[20:23], s74 offen
  buffer_load_dword v20, v2, s[20:23], s75 offen
  s_waitcnt vmcnt(0)
  v_lshlrev_b32 v3, 16, v3
  v_add_f32 v3, v3, v4
  v_add_f32 v3, v3, v5
  v_add_f32 v3, v3, v6
  v_add_f32 v3, v3, v7
  v_add_f32 v3, v3, v8
  v_add_f32 v3, v3, v9
  v_add_f32 v3, v3, v10
  v_add_f32 v3, v3, v11
  v_add_f32 v3, v3, v12
  v_add_f32 v3, v3, v13
  v_add_f32 v3, v3, v14
  v_add_f32 v3, v3, v15
  v_add_f32 v3, v3, v16
  v_add_f32 v3, v3, v17
  v_add_f32 v3, v3, v18
  v_add_f32 v3, v3, v19
  v_add_f32 v3, v3, v20
  v_cvt_pk_bf16_f32 v3, v3, v3
  buffer_store_short v3, v1, s[16:19], 0 offen
K5_END:
  s_endpgm
.section .rodata,"a"
.p2align 6
.amdhsa_kernel k5_fin_kernel
  .amdhsa_next_free_vgpr 24
  .amdhsa_next_free_sgpr 80
  .amdhsa_accum_offset 24
  .amdhsa_group_segment_fixed_size 0
  .amdhsa_kernarg_size 104
  .amdhsa_user_sgpr_count 2
  .amdhsa_user_sgpr_kernarg_segment_ptr 1
  .amdhsa_system_sgpr_workgroup_id_x 1
.end_amdhsa_kernel
```
